```python
import torch

def _softmax(x, axis=-1):
    return torch.softmax(x, dim=axis)
def _gelu(x):
    return torch.nn.functional.gelu(x, approximate="tanh")
def _silu(x):
    return torch.nn.functional.silu(x)
def _sigmoid(x):
    return torch.sigmoid(x)
def _layernorm(x, axis=-1, eps=1e-5):
    m = x.mean(dim=axis, keepdim=True)
    v = x.var(dim=axis, keepdim=True, unbiased=False)
    return (x - m) / torch.sqrt(v + eps)
def _scatter_add(tgt, idx, src, axis=0):
    return tgt.clone().index_add_(axis, idx, src)
def _segment_sum(src, seg, n):
    out = torch.zeros((n,) + src.shape[1:], dtype=src.dtype)
    return out.index_add_(0, seg, src)
def _pad(x, pw):
    flat = tuple(v for pair in reversed(pw) for v in pair)
    return torch.nn.functional.pad(x, flat)

kernel_name = 'gated_mix__grouped_kv_mqa__linear_attn_block__prompt'

def setup_inputs():

    _w = (lambda a: (lambda t: t.to(torch.bfloat16) if t.is_floating_point() else t)(torch.as_tensor(a)))
    def _A_setup():
        B, S, D, H = 1, 2048, 512, 32
        Dh = D // H
        return {
            "x": _w((lambda *s: torch.randn(*s, dtype=torch.bfloat16) * 0.05)(B, S, D)),
            "wq": _w((lambda *s: torch.randn(*s, dtype=torch.bfloat16) * 3.2)(D, H * Dh)),
            "wk": _w((lambda *s: torch.randn(*s, dtype=torch.bfloat16) * 3.2)(D, Dh)),
            "wv": _w((lambda *s: torch.randn(*s, dtype=torch.bfloat16) * 0.1)(D, Dh)),
            "wo": _w((lambda *s: torch.randn(*s, dtype=torch.bfloat16) * 0.1)(H * Dh, D)),
        }
    _A_in = _A_setup()

    def _B_setup():
        B, S, D = 1, 2048, 512
        return {
            "x": _w((lambda *s: torch.randn(*s, dtype=torch.bfloat16) * 0.05)(B, S, D)),
            "wqkv": _w((lambda *s: torch.randn(*s, dtype=torch.bfloat16) * 1.6)(D, 3 * D)),
            "wo": _w((lambda *s: torch.randn(*s, dtype=torch.bfloat16) * 0.4)(D, D)),
        }
    _B_in = _B_setup()

    return {
        "A_x": _A_in["x"],
        "A_wq": _A_in["wq"],
        "A_wk": _A_in["wk"],
        "A_wv": _A_in["wv"],
        "A_wo": _A_in["wo"],
        "B_x": _B_in["x"],
        "B_wqkv": _B_in["wqkv"],
        "B_wo": _B_in["wo"],
        "gate_w": _w((lambda *s: torch.randn(*s, dtype=torch.bfloat16) * 0.05)(512) * 16.0),
    }

def reference(A_x, A_wq, A_wk, A_wv, A_wo, B_x, B_wqkv, B_wo, gate_w):
    def _A_ref(x, wq, wk, wv, wo):
        B, S, D = x.shape
        H = 32
        Dh = D // H
        q = (lambda x, *d: x.permute(*d))((x @ wq).reshape(B, S, H, Dh), 0, 2, 1, 3)
        k = x @ wk
        v = x @ wv
        scores = torch.einsum("bhqd,bkd->bhqk", q, k) * (Dh ** -0.5)
        p = _softmax(scores, axis=-1)
        o = torch.einsum("bhqk,bkd->bhqd", p, v)
        return (lambda x, *d: x.permute(*d))(o, 0, 2, 1, 3).reshape(B, S, H * Dh) @ wo

    def _B_ref(x, wqkv, wo):
        B, S, D = x.shape
        H = 32; Dh = D // H
        qkv = (lambda x, *d: x.permute(*d))((x @ wqkv).reshape(B, S, 3, H, Dh), 2, 0, 3, 1, 4)
        q, k, v = qkv[0], qkv[1], qkv[2]
        phi = lambda t: torch.where(t > 0, t + 1, torch.exp(t)) + 1e-6
        pq, pk = phi(q), phi(k)
        kv = torch.einsum("bhsd,bhse->bhde", pk, v)
        z = torch.einsum("bhsd->bhd", pk)
        num = torch.einsum("bhqd,bhde->bhqe", pq, kv)
        den = torch.einsum("bhqd,bhd->bhq", pq, z)[..., None] + 1e-6
        o = num / den
        return (lambda x, *d: x.permute(*d))(o, 0, 2, 1, 3).reshape(B, S, D) @ wo

    x = A_x
    g = _sigmoid((x * gate_w).sum(-1, keepdims=True))
    a = _A_ref(x, A_wq, A_wk, A_wv, A_wo)
    b = _B_ref(x, B_wqkv, B_wo)
    return g * a + (1 - g) * b
```

```asm
; @launch grid=(256,1,1) block=(768,1,1) lds=163840
.amdgcn_target "amdgcn-amd-amdhsa--gfx950"
.text
.globl gated_mix__grouped_kv_mqa__linear_attn_block__prompt_kernel
.p2align 8
.type gated_mix__grouped_kv_mqa__linear_attn_block__prompt_kernel,@function
gated_mix__grouped_kv_mqa__linear_attn_block__prompt_kernel:
    s_cmp_ge_u32 s2, 256
    s_cbranch_scc1 L_end
    s_load_dwordx16 s[4:19], s[0:1], 0
    s_load_dwordx8 s[20:27], s[0:1], 64
    v_lshrrev_b32 v5, 6, v0
    v_and_b32 v6, 63, v0
    v_readfirstlane_b32 s3, v5
    v_lshlrev_b32 v1, 4, v6
    s_and_b32 s71, s2, 7
    s_lshr_b32 s73, s2, 5
    s_bfe_u32 s74, s2, 131075
    s_lshr_b32 s64, s71, 1
    s_lshl3_add_u32 s64, s64, s73
    s_and_b32 s65, s71, 1
    s_lshl2_add_u32 s86, s65, s74
    s_mov_b32 s65, s86
    s_lshr_b32 s72, s2, 6
    s_lshl2_add_u32 s84, s71, s72
    s_bfe_u32 s85, s2, 0x30003
    v_lshrrev_b32 v8, 4, v6
    v_and_b32 v11, 7, v6
    v_xor_b32 v10, v11, v8
    v_lshlrev_b32 v10, 4, v10
    v_lshrrev_b32 v12, 3, v6
    v_lshl_add_u32 v10, v12, 10, v10
    s_and_b32 s87, s2, 3
    s_bcnt1_i32_b32 s87, s87
    s_and_b32 s87, s87, 1
    s_lshl_b32 s87, s87, 2
    s_mov_b32 s30, 2097152
    s_mov_b32 s31, 0x20000
    s_cmp_ge_u32 s3, 8
    s_cbranch_scc1 L_helper
    s_lshr_b32 s75, s86, 1
    s_lshl2_add_u32 s75, s64, s75
    s_lshl_b32 s75, s75, 4
    s_add_u32 s77, s74, s73
    s_add_u32 s77, s77, s3
    s_and_b32 s77, s77, 3
    s_add_u32 s76, s3, s87
    s_and_b32 s76, s76, 4
    s_or_b32 s77, s77, s76
    s_lshl_b32 s92, s77, 11
    s_lshl_b32 s77, s77, 7
    s_lshl_b32 s76, s75, 10
    s_add_u32 s76, s76, s77
    s_lshl_b32 s94, s3, 12
    s_add_u32 s94, s94, 122880
    s_mov_b32 m0, s94
    v_xor_b32 v11, 64, v10
    v_add_u32 v11, 7168, v11
    v_lshlrev_b32 v9, 4, v8
    v_lshlrev_b32 v88, 2, v6
    v_mov_b32 v89, 155648
    v_and_b32_e64 v7, 15, v0
    s_and_b32 s79, s86, 1
    s_mov_b32 s38, 16384
    s_mov_b32 s39, 0x20000
    s_mov_b32 s42, 1024
    s_mov_b32 s43, 0x20000
    s_cmp_eq_u32 s79, 0
    s_waitcnt lgkmcnt(0)
    s_cselect_b32 s36, s8, s10
    s_cselect_b32 s37, s9, s11
    s_mov_b32 s28, s4
    s_mov_b32 s29, s5
    buffer_load_dwordx4 v1, s[36:39], s92 offen lds
    buffer_load_dwordx4 v1, s[36:39], s92 offen offset:1024 lds
    s_add_u32 m0, s94, 2048
    s_mov_b32 s40, s20
    s_mov_b32 s41, s21
    buffer_load_dwordx4 v10, s[28:31], s76 offen lds
    buffer_load_dwordx4 v11, s[28:31], s76 offen offset:1024 lds
    s_lshl_b32 s71, s3, 8
    s_add_u32 m0, s71, 155648
    v_add3_u32 v89, v9, s71, v89
    buffer_load_dword v88, s[40:43], s77 offen lds
    s_getpc_b64 s[12:13]
L_pc:
    s_and_b32 s71, s2, 0xf8
    s_add_u32 s71, s71, s3
    s_lshl_b32 s71, s71, 7
    s_min_u32 s71, s71, L_codeend-L_pc-4
    v_mov_b32 v90, s71
    global_load_dword v95, v90, s[12:13]
    s_mov_b32 s44, s26
    s_mov_b32 s45, s27
    s_mov_b32 s46, 8388608
    s_mov_b32 s47, 0x20000
    s_mov_b32 s48, s24
    s_mov_b32 s49, s25
    s_mov_b32 s50, 256
    s_mov_b32 s51, 0x20000
    s_mov_b32 s52, s22
    s_mov_b32 s53, s23
    s_mov_b32 s54, 2097152
    s_mov_b32 s55, 0x20000
    s_or_b32 s71, s2, s3
    s_cbranch_scc1 L_nozero
    v_lshrrev_b32 v90, 1, v6
    v_lshlrev_b32 v90, 8, v90
    v_and_b32 v91, 1, v6
    v_lshl_add_u32 v90, v91, 4, v90
    v_mov_b64 v[16:17], 0
    v_mov_b64 v[18:19], 0
    s_mov_b32 s71, 1310720
    buffer_store_dwordx4 v[16:19], v90, s[44:47], s71 offen sc1
    buffer_store_dwordx4 v[16:19], v90, s[44:47], s71 offen offset:64 sc1
    buffer_store_dwordx4 v[16:19], v90, s[44:47], s71 offen offset:128 sc1
L_nozero:
    s_and_b32 s90, s3, 3
    s_lshr_b32 s91, s3, 2
    v_add_u32 v2, 0x10000, v1
    v_mov_b32 v3, 0xdddddddd
    s_mov_b32 s80, 0xffff
    s_mov_b32 s81, 0xffff
    v_lshrrev_b32 v11, 1, v7
    v_xor_b32 v11, v11, v8
    v_lshlrev_b32 v11, 4, v11
    v_lshl_add_u32 v11, v7, 7, v11
    v_mov_b32 v160, v11
    v_xor_b32_e64 v161, 64, v11
    v_add_u32 v158, 81920, v160
    v_add_u32 v159, 81920, v161
    v_add_u32 v154, 124928, v160
    v_add_u32 v155, 124928, v161
    v_add_u32 v9, s94, v11
    v_xor_b32 v10, 64, v9
    v_bfe_u32 v11, v6, 2, 2
    v_lshl_add_u32 v11, v8, 3, v11
    v_and_b32 v12, 3, v6
    v_lshlrev_b32 v12, 3, v12
    v_lshl_add_u32 v13, v11, 5, v12
    v_add_u32 v13, s94, v13
    v_lshl_add_u32 v11, v11, 7, v12
    v_bfe_u32 v12, v6, 3, 2
    v_xor_b32 v12, s90, v12
    v_lshl_add_u32 v11, v12, 5, v11
    v_add_u32 v156, 8192, v11
    v_add_u32 v162, 49152, v11
    v_add_u32 v157, 90112, v11
    s_lshl_b32 s71, s64, 6
    s_lshl2_add_u32 s72, s65, s90
    s_add_u32 s71, s71, s72
    s_lshl_b32 s83, s71, 10
    v_mov_b32 v163, 163776
    v_add_u32_e64 v11, s94, v1
    v_lshl_add_u32 v12, v6, 2, s94
    v_mov_b32 v80, 0x358637bd
    v_mov_b32 v84, 0x3f803f80
    v_mov_b32 v81, 0x358637bd
    v_mov_b32 v85, 0x3f803f80
    v_mov_b32 v82, 0x358637bd
    v_mov_b32 v86, 0x3f803f80
    v_mov_b32 v83, 0x358637bd
    v_mov_b32 v87, 0x3f803f80
    v_mov_b32 v152, 0xb5c1a2a0
    v_mov_b32 v153, 0xb5c1a2a0
    s_mov_b32 s96, 0x3fb8aa3b
    s_mov_b32 s97, 0x3fb8aa3b
    s_mov_b32 s98, 0x3eb8aa3b
    s_mov_b32 s99, 0x3eb8aa3b
    v_lshrrev_b32 v90, 1, v8
    v_mad_u32_u24 v90, v90, 17, v7
    v_and_b32 v91, 1, v8
    v_lshlrev_b32_e64 v91, 4, v91
    v_lshl_add_u32 v90, v90, 5, v91
    s_mul_i32 s71, s90, 1088
    s_add_u32 s71, s71, 131072
    v_add_u32 v165, s71, v90
    s_xor_b32 s71, s65, 1
    s_lshl2_add_u32 s71, s71, s90
    s_mul_i32 s71, s71, 544
    s_add_u32 s71, s71, 139264
    v_and_b32_e64 v90, 31, v0
    v_min_u32 v90, 16, v90
    v_bfe_u32 v91, v0, 5, 1
    v_mad_u32_u24 v90, v91, 17, v90
    v_lshl_add_u32 v166, v90, 4, s71
    s_lshr_b32 s71, s86, 1
    s_lshl1_add_u32 s71, s91, s71
    s_add_u32 s71, s71, 1
    v_bfe_u32 v94, v0, 4, 1
    v_add_u32 v94, s71, v94
    v_and_b32 v94, 3, v94
    v_lshl_add_u32 v90, v94, 4, v7
    s_lshl_b32 s72, s64, 8
    s_add_u32 s72, s72, 131072
    v_lshl_add_u32 v167, v90, 2, s72
    v_lshlrev_b32 v5, 9, v8
    v_lshl_add_u32 v5, v7, 4, v5
    s_lshl_b32 s71, s91, 5
    v_xor_b32 v5, s71, v5
    s_lshr_b32 s71, s90, 1
    s_lshl1_add_u32 s71, s84, s71
    s_lshl2_add_u32 s71, s71, s91
    s_lshl_b32 s71, s71, 13
    s_and_b32 s72, s90, 1
    s_lshl_b32 s72, s72, 8
    s_add_u32 s93, s71, s72
    s_add_u32 s56, s93, 2097152
    s_add_u32 s57, s93, 2101248
    s_add_u32 s58, s93, 2113536
    s_add_u32 s59, s93, 2117632
    s_lshl_b32 s71, s91, 12
    v_add_u32 v14, s71, v1
    v_lshrrev_b32 v92, 1, v8
    v_lshlrev_b32 v92, 9, v92
    v_lshl_add_u32 v92, v7, 4, v92
    v_lshlrev_b32 v93, 2, v7
    v_and_b32 v90, 1, v94
    v_lshl_add_u32 v90, v90, 8, v92
    v_lshrrev_b32 v94, 1, v94
    v_lshl_add_u32 v7, v94, 15, v90
    v_and_b32 v90, 1, v8
    v_lshl_add_u32 v92, v90, 3, v92
    s_lshl_b32 s71, s90, 10
    s_add_u32 s71, s71, 139776
    v_add_u32 v8, s71, v1
    v_add_u32 v90, 122880, v1
    v_lshlrev_b32_e64 v91, 2, v6
    v_add_u32 v91, 122880, v91
    s_lshr_b32 s71, s75, 5
    s_lshl_b32 s71, s71, 11
    s_and_b32 s72, s75, 16
    s_lshl_b32 s72, s72, 4
    s_add_u32 s71, s71, s72
    s_lshl_b32 s72, s79, 10
    s_add_u32 s66, s71, s72
    s_lshl_b32 s72, s75, 2
    s_add_u32 s67, s72, 131072
    v_bfe_u32 v94, v0, 4, 2
    v_bfe_u32 v6, v0, 3, 1
    v_lshl_add_u32 v94, v94, 2, v6
    v_and_b32 v6, 0x70, v1
    v_lshl_add_u32 v6, v94, 10, v6
    s_lshl_b32 s68, s84, 16
    s_lshl3_add_u32 s72, s90, s91
    s_lshl_b32 s72, s72, 11
    s_add_u32 s68, s68, s72
    s_lshl_b32 s72, s85, 7
    s_add_u32 s68, s68, s72
    s_lshl_b32 s71, s3, 11
    s_add_u32 s69, s71, 106496
    s_xor_b32 s71, s71, 8192
    s_add_u32 s70, s71, 106496
    v_mov_b64 v[96:97], 0
    v_mov_b64 v[98:99], 0
    v_mov_b64 v[100:101], 0
    v_mov_b64 v[102:103], 0
    v_mov_b64 v[104:105], 0
    v_mov_b64 v[106:107], 0
    v_mov_b64 v[108:109], 0
    v_mov_b64 v[110:111], 0
    v_mov_b64 v[40:41], 0
    v_mov_b64 v[42:43], 0
    v_mov_b64 v[44:45], 0
    v_mov_b64 v[46:47], 0
    v_mov_b64 v[48:49], 0
    v_mov_b64 v[50:51], 0
    v_mov_b64 v[52:53], 0
    v_mov_b64 v[54:55], 0
    s_mov_b32 exec_lo, 0x00110000
    s_mov_b32 exec_hi, 0x00110000
    v_mov_b64 v[96:97], v[84:85]
    v_mov_b64 v[98:99], v[84:85]
    v_mov_b64 v[100:101], v[84:85]
    v_mov_b64 v[102:103], v[84:85]
    v_mov_b64 v[104:105], v[84:85]
    v_mov_b64 v[106:107], v[84:85]
    v_mov_b64 v[108:109], v[84:85]
    v_mov_b64_e64 v[110:111], v[84:85]
    s_mov_b64 exec, -1
    s_or_b32 s71, s2, s3
    s_waitcnt vmcnt(0) lgkmcnt(0)
    s_cbranch_scc1 L_nogo0
    s_mov_b64 exec, 1
    buffer_store_dword v3, off, s[48:51], 0 sc1
    s_mov_b64 exec, -1
L_nogo0:
    ds_read_b128 v[64:67], v89
    ds_read_b128 v[68:71], v89 offset:64
    ds_read_b128 v[56:59], v9 offset:2048
    ds_read_b128 v[60:63], v10 offset:2048
    ds_read_b64_tr_b16 v[72:73], v13
    ds_read_b64_tr_b16 v[74:75], v13 offset:128
    ds_read_b64_tr_b16 v[76:77], v13 offset:1024
    ds_read_b64_tr_b16 v[78:79], v13 offset:1152
    s_cmp_eq_u32 s79, 0
    s_waitcnt lgkmcnt(4)
    v_mfma_f32_16x16x32_bf16 v[28:31], v[64:67], v[56:59], 0
    v_mfma_f32_16x16x32_bf16 v[28:31], v[68:71], v[60:63], v[28:31]
    s_waitcnt lgkmcnt(0)
    s_cbranch_scc0 L_isV
    v_mfma_f32_16x16x32_bf16 v[24:27], v[72:75], v[56:59], 0
    v_mfma_f32_16x16x32_bf16 v[24:27], v[76:79], v[60:63], v[24:27]
    s_branch L_kvj
L_isV:
    v_mfma_f32_16x16x32_bf16 v[24:27], v[56:59], v[72:75], 0
    v_mfma_f32_16x16x32_bf16 v[24:27], v[60:63], v[76:79], v[24:27]
L_kvj:
    s_nop 5
    ds_write_b32 v12, v28 offset:1024
    s_nop 0
    ds_write_b128 v11, v[24:27]
    s_waitcnt lgkmcnt(0)
    s_barrier
    s_cmp_eq_u32 s3, 3
    s_cbranch_scc0 L_nopub
    ds_read_b128 v[112:115], v90 offset:0
    ds_read_b128 v[116:119], v90 offset:4096
    ds_read_b128 v[120:123], v90 offset:8192
    ds_read_b128 v[124:127], v90 offset:12288
    ds_read_b128 v[128:131], v90 offset:16384
    ds_read_b128 v[132:135], v90 offset:20480
    ds_read_b128 v[136:139], v90 offset:24576
    ds_read_b128 v[140:143], v90 offset:28672
    ds_read_b32 v144, v91 offset:1024
    ds_read_b32 v145, v91 offset:5120
    ds_read_b32 v146, v91 offset:9216
    ds_read_b32 v147, v91 offset:13312
    ds_read_b32 v148, v91 offset:17408
    ds_read_b32 v149, v91 offset:21504
    ds_read_b32 v150, v91 offset:25600
    ds_read_b32 v151, v91 offset:29696
    s_waitcnt lgkmcnt(8)
    v_add_f32 v112, v112, v116
    v_add_f32 v113, v113, v117
    v_add_f32 v114, v114, v118
    v_add_f32 v115, v115, v119
    v_add_f32 v120, v120, v124
    v_add_f32 v121, v121, v125
    v_add_f32 v122, v122, v126
    v_add_f32 v123, v123, v127
    v_add_f32 v128, v128, v132
    v_add_f32 v129, v129, v133
    v_add_f32 v130, v130, v134
    v_add_f32 v131, v131, v135
    v_add_f32 v136, v136, v140
    v_add_f32 v137, v137, v141
    v_add_f32 v138, v138, v142
    v_add_f32 v139, v139, v143
    v_add_f32 v112, v112, v120
    v_add_f32 v113, v113, v121
    v_add_f32 v114, v114, v122
    v_add_f32 v115, v115, v123
    v_add_f32 v128, v128, v136
    v_add_f32 v129, v129, v137
    v_add_f32 v130, v130, v138
    v_add_f32 v131, v131, v139
    v_add_f32 v112, v112, v128
    v_add_f32 v113, v113, v129
    v_add_f32 v114, v114, v130
    v_add_f32_e64 v115, v115, v131
    s_lshl_b32 s73, s79, 5
    v_ldexp_f32 v112, v112, s73
    v_ldexp_f32 v113, v113, s73
    v_ldexp_f32 v114, v114, s73
    v_ldexp_f32 v115, v115, s73
    v_cvt_pk_bf16_f32 v16, v112, v113
    v_cvt_pk_bf16_f32 v17, v114, v115
    buffer_store_dwordx2 v[16:17], v92, s[44:47], s66 offen sc1
    s_waitcnt lgkmcnt(0)
    v_add_f32 v144, v144, v146
    v_add_f32 v145, v145, v147
    v_add_f32 v148, v148, v150
    v_add_f32 v149, v149, v151
    v_add_f32 v144, v144, v148
    v_add_f32 v145, v145, v149
    v_add_f32 v144, v144, v145
    v_mul_f32 v144, 0xbfb8aa3b, v144
    v_exp_f32 v144, v144
    s_nop 0
    v_add_f32 v144, 1.0, v144
    v_rcp_f32_e64 v18, v144
    s_mov_b64 exec, 0xffff
    buffer_store_dword v18, v93, s[44:47], s67 offen sc1
    s_mov_b64 exec, -1
    buffer_load_dword v11, off, s[48:51], 0 sc1
L_nopub:
    s_cmp_eq_u32 s91, 0
    s_cbranch_scc0 L_tyK
    ds_read_b64_tr_b16 v[72:73], v162 offset:0
    ds_read_b64_tr_b16 v[74:75], v162 offset:512
    ds_read_b128 v[56:59], v160 offset:40960
    ds_read_b64_tr_b16 v[76:77], v162 offset:8192
    ds_read_b64_tr_b16 v[78:79], v162 offset:8704
    ds_read_b128 v[60:63], v160 offset:43008
    ds_read_b128 v[64:67], v160 offset:45056
    ds_read_b128 v[68:71], v154 offset:0
    s_waitcnt lgkmcnt(5)
    v_mfma_f32_16x16x32_bf16 v[24:27], v[72:75], v[56:59], 0
    ds_read_b64_tr_b16 v[128:129], v162 offset:4096
    ds_read_b64_tr_b16 v[130:131], v162 offset:4608
    s_waitcnt lgkmcnt(5)
    v_mfma_f32_16x16x32_bf16 v[136:139], v[76:79], v[56:59], v[80:83]
    ds_read_b128 v[112:115], v161 offset:40960
    s_waitcnt lgkmcnt(5)
    v_mfma_f32_16x16x32_bf16 v[28:31], v[72:75], v[60:63], 0
    v_mfma_f32_16x16x32_bf16 v[140:143], v[76:79], v[60:63], v[80:83]
    ds_read_b64_tr_b16 v[132:133], v162 offset:12288
    s_waitcnt lgkmcnt(5)
    v_mfma_f32_16x16x32_bf16 v[32:35], v[72:75], v[64:67], 0
    v_mfma_f32_16x16x32_bf16 v[144:147], v[76:79], v[64:67], v[80:83]
    ds_read_b64_tr_b16 v[134:135], v162 offset:12800
    s_waitcnt lgkmcnt(5)
    v_mfma_f32_16x16x32_bf16 v[36:39], v[72:75], v[68:71], 0
    v_mfma_f32_16x16x32_bf16 v[148:151], v[76:79], v[68:71], v[80:83]
    ds_read_b128 v[116:119], v161 offset:43008
    ds_read_b128 v[120:123], v161 offset:45056
    ds_read_b128 v[124:127], v155 offset:0
    s_waitcnt lgkmcnt(5)
    v_mfma_f32_16x16x32_bf16 v[24:27], v[128:131], v[112:115], v[24:27]
    s_waitcnt lgkmcnt(3)
    v_mfma_f32_16x16x32_bf16 v[136:139], v[132:135], v[112:115], v[136:139]
    s_waitcnt lgkmcnt(2)
    v_mfma_f32_16x16x32_bf16 v[28:31], v[128:131], v[116:119], v[28:31]
    v_mfma_f32_16x16x32_bf16 v[140:143], v[132:135], v[116:119], v[140:143]
    s_waitcnt lgkmcnt(0)
    s_barrier
    ds_read_b64_tr_b16 v[72:73], v157 offset:0
    ds_read_b64_tr_b16 v[74:75], v157 offset:512
    v_mfma_f32_16x16x32_bf16 v[32:35], v[128:131], v[120:123], v[32:35]
    ds_read_b128 v[56:59], v158 offset:0
    ds_read_b64_tr_b16 v[76:77], v157 offset:8192
    v_mfma_f32_16x16x32_bf16 v[144:147], v[132:135], v[120:123], v[144:147]
    ds_read_b64_tr_b16 v[78:79], v157 offset:8704
    ds_read_b128 v[60:63], v158 offset:2048
    v_mfma_f32_16x16x32_bf16 v[36:39], v[128:131], v[124:127], v[36:39]
    ds_read_b128 v[64:67], v158 offset:4096
    ds_read_b128 v[68:71], v154 offset:4096
    v_mfma_f32_16x16x32_bf16 v[148:151], v[132:135], v[124:127], v[148:151]
    s_waitcnt lgkmcnt(5)
    v_mfma_f32_16x16x32_bf16 v[24:27], v[72:75], v[56:59], v[24:27]
    ds_read_b64_tr_b16 v[128:129], v157 offset:4096
    ds_read_b64_tr_b16 v[130:131], v157 offset:4608
    s_waitcnt lgkmcnt(5)
    v_mfma_f32_16x16x32_bf16 v[136:139], v[76:79], v[56:59], v[136:139]
    ds_read_b128 v[112:115], v159 offset:0
    s_waitcnt lgkmcnt(5)
    v_mfma_f32_16x16x32_bf16 v[28:31], v[72:75], v[60:63], v[28:31]
    v_mfma_f32_16x16x32_bf16 v[140:143], v[76:79], v[60:63], v[140:143]
    ds_read_b64_tr_b16 v[132:133], v157 offset:12288
    s_waitcnt lgkmcnt(5)
    v_mfma_f32_16x16x32_bf16 v[32:35], v[72:75], v[64:67], v[32:35]
    v_mfma_f32_16x16x32_bf16 v[144:147], v[76:79], v[64:67], v[144:147]
    ds_read_b64_tr_b16 v[134:135], v157 offset:12800
    s_waitcnt lgkmcnt(5)
    v_mfma_f32_16x16x32_bf16 v[36:39], v[72:75], v[68:71], v[36:39]
    v_mfma_f32_16x16x32_bf16 v[148:151], v[76:79], v[68:71], v[148:151]
    ds_read_b128 v[116:119], v159 offset:2048
    ds_read_b128 v[120:123], v159 offset:4096
    ds_read_b128 v[124:127], v155 offset:4096
    s_waitcnt lgkmcnt(5)
    v_mfma_f32_16x16x32_bf16 v[24:27], v[128:131], v[112:115], v[24:27]
    s_waitcnt lgkmcnt(3)
    v_mfma_f32_16x16x32_bf16 v[136:139], v[132:135], v[112:115], v[136:139]
    s_waitcnt lgkmcnt(2)
    v_mfma_f32_16x16x32_bf16 v[28:31], v[128:131], v[116:119], v[28:31]
    v_mfma_f32_16x16x32_bf16 v[140:143], v[132:135], v[116:119], v[140:143]
    s_waitcnt lgkmcnt(0)
    s_barrier
    ds_read_b64_tr_b16 v[72:73], v156 offset:0
    ds_read_b64_tr_b16 v[74:75], v156 offset:512
    v_mfma_f32_16x16x32_bf16 v[32:35], v[128:131], v[120:123], v[32:35]
    ds_read_b128 v[56:59], v160 offset:0
    ds_read_b64_tr_b16 v[76:77], v156 offset:8192
    v_mfma_f32_16x16x32_bf16 v[144:147], v[132:135], v[120:123], v[144:147]
    ds_read_b64_tr_b16 v[78:79], v156 offset:8704
    ds_read_b128 v[60:63], v160 offset:2048
    v_mfma_f32_16x16x32_bf16 v[36:39], v[128:131], v[124:127], v[36:39]
    ds_read_b128 v[64:67], v160 offset:4096
    ds_read_b128 v[68:71], v154 offset:8192
    v_mfma_f32_16x16x32_bf16 v[148:151], v[132:135], v[124:127], v[148:151]
    s_waitcnt lgkmcnt(5)
    v_mfma_f32_16x16x32_bf16 v[24:27], v[72:75], v[56:59], v[24:27]
    ds_read_b64_tr_b16 v[128:129], v156 offset:4096
    ds_read_b64_tr_b16 v[130:131], v156 offset:4608
    s_waitcnt lgkmcnt(5)
    v_mfma_f32_16x16x32_bf16 v[136:139], v[76:79], v[56:59], v[136:139]
    ds_read_b128 v[112:115], v161 offset:0
    s_waitcnt lgkmcnt(5)
    v_mfma_f32_16x16x32_bf16 v[28:31], v[72:75], v[60:63], v[28:31]
    v_mfma_f32_16x16x32_bf16 v[140:143], v[76:79], v[60:63], v[140:143]
    ds_read_b64_tr_b16 v[132:133], v156 offset:12288
    s_waitcnt lgkmcnt(5)
    v_mfma_f32_16x16x32_bf16 v[32:35], v[72:75], v[64:67], v[32:35]
    v_mfma_f32_16x16x32_bf16 v[144:147], v[76:79], v[64:67], v[144:147]
    ds_read_b64_tr_b16 v[134:135], v156 offset:12800
    s_waitcnt lgkmcnt(5)
    v_mfma_f32_16x16x32_bf16 v[36:39], v[72:75], v[68:71], v[36:39]
    v_mfma_f32_16x16x32_bf16 v[148:151], v[76:79], v[68:71], v[148:151]
    ds_read_b128 v[116:119], v161 offset:2048
    ds_read_b128 v[120:123], v161 offset:4096
    ds_read_b128 v[124:127], v155 offset:8192
    s_waitcnt lgkmcnt(5)
    v_mfma_f32_16x16x32_bf16 v[24:27], v[128:131], v[112:115], v[24:27]
    s_waitcnt lgkmcnt(3)
    v_mfma_f32_16x16x32_bf16 v[136:139], v[132:135], v[112:115], v[136:139]
    s_waitcnt lgkmcnt(2)
    v_mfma_f32_16x16x32_bf16 v[28:31], v[128:131], v[116:119], v[28:31]
    v_mfma_f32_16x16x32_bf16 v[140:143], v[132:135], v[116:119], v[140:143]
    s_waitcnt lgkmcnt(0)
    s_cmp_eq_u32 s3, 3
    s_cbranch_scc0 L_nosig1
    s_mov_b32 s82, 262144
L_go0:
    s_waitcnt vmcnt(0)
    v_cmp_ne_u32 vcc, 0, v11
    s_sub_u32 s82, s82, 1
    s_cbranch_vccnz L_go0d
    buffer_load_dword v11, off, s[48:51], 0 sc1
    s_cbranch_scc0 L_go0
L_go0d:
    s_lshr_b32 s71, s2, 3
    s_lshl_b32 s71, s71, 8
    s_and_b32 s72, s2, 7
    s_lshl2_add_u32 s71, s72, s71
    s_add_u32 s71, s71, 1310720
    v_mov_b32 v12, 1
    s_mov_b64 exec, 1
    buffer_store_dword v12, off, s[44:47], s71 sc1
    s_mov_b64 exec, -1
L_nosig1:
    s_barrier
    ds_read_b64_tr_b16 v[72:73], v162 offset:0
    ds_read_b64_tr_b16 v[74:75], v162 offset:512
    v_mfma_f32_16x16x32_bf16 v[32:35], v[128:131], v[120:123], v[32:35]
    ds_read_b128 v[56:59], v160 offset:40960
    ds_read_b64_tr_b16 v[76:77], v162 offset:8192
    v_mfma_f32_16x16x32_bf16 v[144:147], v[132:135], v[120:123], v[144:147]
    ds_read_b64_tr_b16 v[78:79], v162 offset:8704
    ds_read_b128 v[60:63], v160 offset:43008
    v_mfma_f32_16x16x32_bf16 v[36:39], v[128:131], v[124:127], v[36:39]
    ds_read_b128 v[64:67], v160 offset:45056
    ds_read_b128 v[68:71], v154 offset:12288
    v_mfma_f32_16x16x32_bf16 v[148:151], v[132:135], v[124:127], v[148:151]
    s_waitcnt lgkmcnt(5)
    v_mfma_f32_16x16x32_bf16 v[24:27], v[72:75], v[56:59], v[24:27]
    ds_read_b64_tr_b16 v[128:129], v162 offset:4096
    ds_read_b64_tr_b16 v[130:131], v162 offset:4608
    s_waitcnt lgkmcnt(5)
    v_mfma_f32_16x16x32_bf16 v[136:139], v[76:79], v[56:59], v[136:139]
    ds_read_b128 v[112:115], v161 offset:40960
    s_waitcnt lgkmcnt(5)
    v_mfma_f32_16x16x32_bf16 v[28:31], v[72:75], v[60:63], v[28:31]
    v_mfma_f32_16x16x32_bf16 v[140:143], v[76:79], v[60:63], v[140:143]
    ds_read_b64_tr_b16 v[132:133], v162 offset:12288
    s_waitcnt lgkmcnt(5)
    v_mfma_f32_16x16x32_bf16 v[32:35], v[72:75], v[64:67], v[32:35]
    v_mfma_f32_16x16x32_bf16 v[144:147], v[76:79], v[64:67], v[144:147]
    ds_read_b64_tr_b16 v[134:135], v162 offset:12800
    s_waitcnt lgkmcnt(5)
    v_mfma_f32_16x16x32_bf16 v[36:39], v[72:75], v[68:71], v[36:39]
    v_mfma_f32_16x16x32_bf16 v[148:151], v[76:79], v[68:71], v[148:151]
    ds_read_b128 v[116:119], v161 offset:43008
    ds_read_b128 v[120:123], v161 offset:45056
    ds_read_b128 v[124:127], v155 offset:12288
    s_waitcnt lgkmcnt(5)
    v_mfma_f32_16x16x32_bf16 v[24:27], v[128:131], v[112:115], v[24:27]
    s_waitcnt lgkmcnt(3)
    v_mfma_f32_16x16x32_bf16 v[136:139], v[132:135], v[112:115], v[136:139]
    s_waitcnt lgkmcnt(2)
    v_mfma_f32_16x16x32_bf16 v[28:31], v[128:131], v[116:119], v[28:31]
    v_mfma_f32_16x16x32_bf16 v[140:143], v[132:135], v[116:119], v[140:143]
    s_waitcnt lgkmcnt(0)
    v_mov_b32_e64 v13, 1
    v_mov_b32 v12, 0x79000000
    s_barrier
    ds_read_b64_tr_b16 v[72:73], v157 offset:0
    ds_read_b64_tr_b16 v[74:75], v157 offset:512
    v_mfma_f32_16x16x32_bf16 v[32:35], v[128:131], v[120:123], v[32:35]
    ds_read_b128 v[56:59], v158 offset:0
    ds_read_b64_tr_b16 v[76:77], v157 offset:8192
    v_mfma_f32_16x16x32_bf16 v[144:147], v[132:135], v[120:123], v[144:147]
    ds_read_b64_tr_b16 v[78:79], v157 offset:8704
    ds_read_b128 v[60:63], v158 offset:2048
    v_mfma_f32_16x16x32_bf16 v[36:39], v[128:131], v[124:127], v[36:39]
    ds_read_b128 v[64:67], v158 offset:4096
    ds_read_b128 v[68:71], v154 offset:16384
    v_mfma_f32_16x16x32_bf16 v[148:151], v[132:135], v[124:127], v[148:151]
    s_waitcnt lgkmcnt(5)
    v_mfma_f32_16x16x32_bf16 v[24:27], v[72:75], v[56:59], v[24:27]
    ds_read_b64_tr_b16 v[128:129], v157 offset:4096
    ds_read_b64_tr_b16 v[130:131], v157 offset:4608
    s_waitcnt lgkmcnt(5)
    v_mfma_f32_16x16x32_bf16 v[136:139], v[76:79], v[56:59], v[136:139]
    ds_read_b128 v[112:115], v159 offset:0
    s_waitcnt lgkmcnt(5)
    v_mfma_f32_16x16x32_bf16 v[28:31], v[72:75], v[60:63], v[28:31]
    v_mfma_f32_16x16x32_bf16 v[140:143], v[76:79], v[60:63], v[140:143]
    ds_read_b64_tr_b16 v[132:133], v157 offset:12288
    s_waitcnt lgkmcnt(5)
    v_mfma_f32_16x16x32_bf16 v[32:35], v[72:75], v[64:67], v[32:35]
    v_mfma_f32_16x16x32_bf16 v[144:147], v[76:79], v[64:67], v[144:147]
    ds_read_b64_tr_b16 v[134:135], v157 offset:12800
    s_waitcnt lgkmcnt(5)
    v_mfma_f32_16x16x32_bf16 v[36:39], v[72:75], v[68:71], v[36:39]
    v_mfma_f32_16x16x32_bf16 v[148:151], v[76:79], v[68:71], v[148:151]
    ds_read_b128 v[116:119], v159 offset:2048
    ds_read_b128 v[120:123], v159 offset:4096
    ds_read_b128 v[124:127], v155 offset:16384
    s_waitcnt lgkmcnt(5)
    v_mfma_f32_16x16x32_bf16 v[24:27], v[128:131], v[112:115], v[24:27]
    s_waitcnt lgkmcnt(3)
    v_mfma_f32_16x16x32_bf16 v[136:139], v[132:135], v[112:115], v[136:139]
    s_waitcnt lgkmcnt(2)
    v_mfma_f32_16x16x32_bf16 v[28:31], v[128:131], v[116:119], v[28:31]
    v_mfma_f32_16x16x32_bf16 v[140:143], v[132:135], v[116:119], v[140:143]
    s_waitcnt lgkmcnt(0)
    s_barrier
    ds_read_b64_tr_b16 v[72:73], v156 offset:0
    ds_read_b64_tr_b16 v[74:75], v156 offset:512
    v_mfma_f32_16x16x32_bf16 v[32:35], v[128:131], v[120:123], v[32:35]
    ds_read_b128 v[56:59], v160 offset:0
    ds_read_b64_tr_b16 v[76:77], v156 offset:8192
    v_mfma_f32_16x16x32_bf16 v[144:147], v[132:135], v[120:123], v[144:147]
    ds_read_b64_tr_b16 v[78:79], v156 offset:8704
    ds_read_b128 v[60:63], v160 offset:2048
    v_mfma_f32_16x16x32_bf16 v[36:39], v[128:131], v[124:127], v[36:39]
    ds_read_b128 v[64:67], v160 offset:4096
    ds_read_b128 v[68:71], v154 offset:20480
    v_mfma_f32_16x16x32_bf16 v[148:151], v[132:135], v[124:127], v[148:151]
    s_waitcnt lgkmcnt(5)
    v_mfma_f32_16x16x32_bf16 v[24:27], v[72:75], v[56:59], v[24:27]
    ds_read_b64_tr_b16 v[128:129], v156 offset:4096
    ds_read_b64_tr_b16 v[130:131], v156 offset:4608
    s_waitcnt lgkmcnt(5)
    v_mfma_f32_16x16x32_bf16 v[136:139], v[76:79], v[56:59], v[136:139]
    ds_read_b128 v[112:115], v161 offset:0
    s_waitcnt lgkmcnt(5)
    v_mfma_f32_16x16x32_bf16 v[28:31], v[72:75], v[60:63], v[28:31]
    v_mfma_f32_16x16x32_bf16 v[140:143], v[76:79], v[60:63], v[140:143]
    ds_read_b64_tr_b16 v[132:133], v156 offset:12288
    s_waitcnt lgkmcnt(5)
    v_mfma_f32_16x16x32_bf16 v[32:35], v[72:75], v[64:67], v[32:35]
    v_mfma_f32_16x16x32_bf16 v[144:147], v[76:79], v[64:67], v[144:147]
    ds_read_b64_tr_b16 v[134:135], v156 offset:12800
    s_waitcnt lgkmcnt(5)
    v_mfma_f32_16x16x32_bf16 v[36:39], v[72:75], v[68:71], v[36:39]
    v_mfma_f32_16x16x32_bf16 v[148:151], v[76:79], v[68:71], v[148:151]
    ds_read_b128 v[116:119], v161 offset:2048
    ds_read_b128 v[120:123], v161 offset:4096
    ds_read_b128 v[124:127], v155 offset:20480
    s_waitcnt lgkmcnt(5)
    v_mfma_f32_16x16x32_bf16 v[24:27], v[128:131], v[112:115], v[24:27]
    s_waitcnt lgkmcnt(3)
    v_mfma_f32_16x16x32_bf16 v[136:139], v[132:135], v[112:115], v[136:139]
    s_waitcnt lgkmcnt(2)
    v_mfma_f32_16x16x32_bf16 v[28:31], v[128:131], v[116:119], v[28:31]
    v_mfma_f32_16x16x32_bf16 v[140:143], v[132:135], v[116:119], v[140:143]
    s_waitcnt lgkmcnt(0)
    s_barrier
    ds_read_b64_tr_b16 v[72:73], v162 offset:0
    ds_read_b64_tr_b16 v[74:75], v162 offset:512
    v_mfma_f32_16x16x32_bf16 v[32:35], v[128:131], v[120:123], v[32:35]
    ds_read_b128 v[56:59], v160 offset:40960
    ds_read_b64_tr_b16 v[76:77], v162 offset:8192
    v_mfma_f32_16x16x32_bf16 v[144:147], v[132:135], v[120:123], v[144:147]
    ds_read_b64_tr_b16 v[78:79], v162 offset:8704
    ds_read_b128 v[60:63], v160 offset:43008
    v_mfma_f32_16x16x32_bf16 v[36:39], v[128:131], v[124:127], v[36:39]
    ds_read_b128 v[64:67], v160 offset:45056
    ds_read_b128 v[68:71], v154 offset:24576
    v_mfma_f32_16x16x32_bf16 v[148:151], v[132:135], v[124:127], v[148:151]
    s_waitcnt lgkmcnt(5)
    v_mfma_f32_16x16x32_bf16 v[24:27], v[72:75], v[56:59], v[24:27]
    ds_read_b64_tr_b16 v[128:129], v162 offset:4096
    ds_read_b64_tr_b16 v[130:131], v162 offset:4608
    s_waitcnt lgkmcnt(5)
    v_mfma_f32_16x16x32_bf16 v[136:139], v[76:79], v[56:59], v[136:139]
    ds_read_b128 v[112:115], v161 offset:40960
    s_waitcnt lgkmcnt(5)
    v_mfma_f32_16x16x32_bf16 v[28:31], v[72:75], v[60:63], v[28:31]
    v_mfma_f32_16x16x32_bf16 v[140:143], v[76:79], v[60:63], v[140:143]
    ds_read_b64_tr_b16 v[132:133], v162 offset:12288
    s_waitcnt lgkmcnt(5)
    v_mfma_f32_16x16x32_bf16 v[32:35], v[72:75], v[64:67], v[32:35]
    v_mfma_f32_16x16x32_bf16 v[144:147], v[76:79], v[64:67], v[144:147]
    ds_read_b64_tr_b16 v[134:135], v162 offset:12800
    s_waitcnt lgkmcnt(5)
    v_mfma_f32_16x16x32_bf16 v[36:39], v[72:75], v[68:71], v[36:39]
    v_mfma_f32_16x16x32_bf16 v[148:151], v[76:79], v[68:71], v[148:151]
    ds_read_b128 v[116:119], v161 offset:43008
    ds_read_b128 v[120:123], v161 offset:45056
    ds_read_b128 v[124:127], v155 offset:24576
    s_waitcnt lgkmcnt(5)
    v_mfma_f32_16x16x32_bf16 v[24:27], v[128:131], v[112:115], v[24:27]
    s_waitcnt lgkmcnt(3)
    v_mfma_f32_16x16x32_bf16 v[136:139], v[132:135], v[112:115], v[136:139]
    s_waitcnt lgkmcnt(2)
    v_mfma_f32_16x16x32_bf16 v[28:31], v[128:131], v[116:119], v[28:31]
    v_mfma_f32_16x16x32_bf16 v[140:143], v[132:135], v[116:119], v[140:143]
    s_waitcnt lgkmcnt(0)
    s_setprio 1
    s_barrier
    ds_read_b64_tr_b16 v[72:73], v157 offset:0
    ds_read_b64_tr_b16 v[74:75], v157 offset:512
    v_mfma_f32_16x16x32_bf16 v[32:35], v[128:131], v[120:123], v[32:35]
    ds_read_b128 v[56:59], v158 offset:0
    ds_read_b64_tr_b16 v[76:77], v157 offset:8192
    v_mfma_f32_16x16x32_bf16 v[144:147], v[132:135], v[120:123], v[144:147]
    ds_read_b64_tr_b16 v[78:79], v157 offset:8704
    ds_read_b128 v[60:63], v158 offset:2048
    v_mfma_f32_16x16x32_bf16 v[36:39], v[128:131], v[124:127], v[36:39]
    ds_read_b128 v[64:67], v158 offset:4096
    ds_read_b128 v[68:71], v154 offset:28672
    v_mfma_f32_16x16x32_bf16 v[148:151], v[132:135], v[124:127], v[148:151]
    s_waitcnt lgkmcnt(5)
    v_mfma_f32_16x16x32_bf16 v[24:27], v[72:75], v[56:59], v[24:27]
    ds_read_b64_tr_b16 v[128:129], v157 offset:4096
    ds_read_b64_tr_b16 v[130:131], v157 offset:4608
    s_waitcnt lgkmcnt(5)
    v_mfma_f32_16x16x32_bf16 v[136:139], v[76:79], v[56:59], v[136:139]
    ds_read_b128 v[112:115], v159 offset:0
    s_waitcnt lgkmcnt(5)
    v_mfma_f32_16x16x32_bf16 v[28:31], v[72:75], v[60:63], v[28:31]
    v_mfma_f32_16x16x32_bf16 v[140:143], v[76:79], v[60:63], v[140:143]
    ds_read_b64_tr_b16 v[132:133], v157 offset:12288
    s_waitcnt lgkmcnt(5)
    v_mfma_f32_16x16x32_bf16 v[32:35], v[72:75], v[64:67], v[32:35]
    v_mfma_f32_16x16x32_bf16 v[144:147], v[76:79], v[64:67], v[144:147]
    ds_read_b64_tr_b16 v[134:135], v157 offset:12800
    s_waitcnt lgkmcnt(5)
    v_mfma_f32_16x16x32_bf16 v[36:39], v[72:75], v[68:71], v[36:39]
    v_mfma_f32_16x16x32_bf16 v[148:151], v[76:79], v[68:71], v[148:151]
    ds_read_b128 v[116:119], v159 offset:2048
    ds_read_b128 v[120:123], v159 offset:4096
    ds_read_b128 v[124:127], v155 offset:28672
    s_waitcnt lgkmcnt(5)
    v_mfma_f32_16x16x32_bf16 v[24:27], v[128:131], v[112:115], v[24:27]
    s_waitcnt lgkmcnt(3)
    v_mfma_f32_16x16x32_bf16 v[136:139], v[132:135], v[112:115], v[136:139]
    s_waitcnt lgkmcnt(2)
    v_mfma_f32_16x16x32_bf16 v[28:31], v[128:131], v[116:119], v[28:31]
    v_mfma_f32_16x16x32_bf16 v[140:143], v[132:135], v[116:119], v[140:143]
    s_waitcnt lgkmcnt(1)
    v_mfma_f32_16x16x32_bf16 v[32:35], v[128:131], v[120:123], v[32:35]
    v_mfma_f32_16x16x32_bf16 v[144:147], v[132:135], v[120:123], v[144:147]
    s_waitcnt lgkmcnt(0)
    v_mfma_f32_16x16x32_bf16 v[36:39], v[128:131], v[124:127], v[36:39]
    v_mfma_f32_16x16x32_bf16 v[148:151], v[132:135], v[124:127], v[148:151]
    s_setprio 0
    v_mul_f32 v24, s98, v24
    v_mul_f32 v25, s98, v25
    v_mul_f32 v26, s98, v26
    v_mul_f32 v27, s98, v27
    v_mul_f32 v28, s98, v28
    v_mul_f32 v29, s98, v29
    v_mul_f32 v30, s98, v30
    v_mul_f32 v31, s98, v31
    v_cvt_pk_bf16_f32 v16, v24, v25
    v_cvt_pk_bf16_f32 v17, v26, v27
    v_cvt_pk_bf16_f32 v18, v28, v29
    v_cvt_pk_bf16_f32 v19, v30, v31
    v_mul_f32 v32, s98, v32
    v_mul_f32 v33, s98, v33
    v_mul_f32 v34, s98, v34
    v_mul_f32 v35, s98, v35
    v_mul_f32 v36, s98, v36
    v_mul_f32 v37, s98, v37
    v_mul_f32 v38, s98, v38
    v_mul_f32 v39, s98, v39
    v_cvt_pk_bf16_f32 v72, v32, v33
    v_cvt_pk_bf16_f32 v73, v34, v35
    v_cvt_pk_bf16_f32 v74, v36, v37
    v_cvt_pk_bf16_f32 v75, v38, v39
    v_permlane16_swap_b32 v16, v18
    v_permlane16_swap_b32 v17, v19
    v_permlane16_swap_b32 v72, v74
    v_permlane16_swap_b32 v73, v75
    ds_write_b128 v8, v[72:75]
    v_fma_f32 v116, v144, s96, v152
    v_fma_f32 v117, v145, s96, v152
    v_fma_f32 v118, v146, s96, v152
    v_fma_f32 v119, v147, s96, v152
    v_fma_f32 v120, v148, s96, v152
    v_fma_f32 v121, v149, s96, v152
    v_fma_f32 v122, v150, s96, v152
    v_fma_f32 v123, v151, s96, v152
    s_waitcnt lgkmcnt(0)
    s_barrier
    s_setprio 2
    ds_read_b128 v[112:115], v1 offset:0
    v_exp_f32 v116, v116 clamp
    v_exp_f32 v117, v117 clamp
    v_exp_f32 v118, v118 clamp
    v_exp_f32 v119, v119 clamp
    v_exp_f32 v120, v120 clamp
    v_exp_f32 v121, v121 clamp
    v_exp_f32 v122, v122 clamp
    v_exp_f32 v123, v123 clamp
    v_max_f32 v144, v144, v80
    v_max_f32 v145, v145, v80
    v_max_f32 v146, v146, v80
    v_max_f32 v147, v147, v80
    v_max_f32 v148, v148, v80
    v_max_f32 v149, v149, v80
    v_max_f32 v150, v150, v80
    v_max_f32 v151, v151, v80
    s_waitcnt lgkmcnt(0)
    v_mfma_f32_32x32x16_bf16 v[56:71], v[112:115], v[16:19], 0
    ds_read_b128 v[88:91], v1 offset:2048
    ds_read_b128 v[92:95], v1 offset:4096
    s_mov_b64 exec, s[80:81]
    ds_read_b128 v[96:99], v1 offset:1024
    ds_read_b128 v[108:111], v1 offset:1280
    ds_read_b128 v[104:107], v1 offset:3072
    s_mov_b64 exec, -1
    v_add_f32 v144, v144, v116
    v_add_f32 v145, v145, v117
    v_add_f32 v146, v146, v118
    v_add_f32 v147, v147, v119
    v_add_f32 v148, v148, v120
    v_add_f32 v149, v149, v121
    v_add_f32 v150, v150, v122
    v_add_f32 v151, v151, v123
    v_max3_f32 v10, v56, v57, v58
    v_max3_f32 v11, v59, v60, v61
    v_max3_f32 v10, v10, v62, v63
    v_max3_f32 v11, v11, v64, v65
    v_max3_f32 v10, v10, v66, v67
    v_max3_f32 v11, v11, v68, v69
    v_max3_f32 v10, v10, v70, v71
    v_max_f32 v10, v10, v11
    v_mov_b32 v11, v10
    v_cvt_pk_bf16_f32 v76, v144, v145
    v_cvt_pk_bf16_f32 v77, v146, v147
    v_permlane32_swap_b32 v10, v11
    v_max_f32 v10, v10, v11
    v_sub_f32 v24, 0xc2c80000, v10
    v_ceil_f32 v24, v24
    v_mov_b32 v25, v24
    v_mov_b64 v[26:27], v[24:25]
    v_mov_b64 v[28:29], v[24:25]
    v_mov_b64 v[30:31], v[24:25]
    v_mov_b64 v[32:33], v[24:25]
    v_mov_b64 v[34:35], v[24:25]
    v_mov_b64 v[36:37], v[24:25]
    v_mov_b64_e64 v[38:39], v[24:25]
    v_cvt_pk_bf16_f32 v78, v148, v149
    v_cvt_pk_bf16_f32 v79, v150, v151
    v_mfma_f32_32x32x16_bf16 v[56:71], v[112:115], v[16:19], v[24:39]
    v_fma_f32 v124, v136, s96, v152
    v_fma_f32 v125, v137, s96, v152
    v_permlane16_swap_b32 v76, v78
    v_permlane16_swap_b32 v77, v79
    ds_write_b128 v8, v[76:79] offset:17920
    v_fma_f32 v126, v138, s96, v152
    v_fma_f32 v127, v139, s96, v152
    v_fma_f32 v128, v140, s96, v152
    v_fma_f32 v129, v141, s96, v152
    v_fma_f32 v130, v142, s96, v152
    v_fma_f32 v131, v143, s96, v152
    v_exp_f32 v124, v124 clamp
    v_exp_f32 v125, v125 clamp
    v_exp_f32 v126, v126 clamp
    v_exp_f32 v127, v127 clamp
    v_exp_f32 v128, v128 clamp
    v_exp_f32 v129, v129 clamp
    v_exp_f32 v130, v130 clamp
    v_exp_f32 v131, v131 clamp
    v_max_f32 v136, v136, v80
    v_max_f32 v137, v137, v80
    v_max_f32 v138, v138, v80
    v_max_f32 v139, v139, v80
    v_max_f32 v140, v140, v80
    v_max_f32 v141, v141, v80
    v_max_f32 v142, v142, v80
    v_max_f32 v143, v143, v80
    v_pk_add_f32 v[136:137], v[136:137], v[124:125]
    v_pk_add_f32 v[138:139], v[138:139], v[126:127]
    v_pk_add_f32 v[140:141], v[140:141], v[128:129]
    v_pk_add_f32 v[142:143], v[142:143], v[130:131]
    v_cvt_pk_bf16_f32 v20, v136, v137
    v_cvt_pk_bf16_f32 v21, v138, v139
    v_cvt_pk_bf16_f32 v22, v140, v141
    v_cvt_pk_bf16_f32 v23, v142, v143
    s_mov_b64 exec, 1
    s_waitcnt lgkmcnt(0)
    ds_add_u32 v163, v13 offset:28
    s_mov_b64 exec, -1
    v_permlane16_swap_b32 v20, v22
    v_permlane16_swap_b32 v21, v23
    s_branch L_att
L_tyK:
    ds_read_b64_tr_b16 v[72:73], v162 offset:16384
    ds_read_b64_tr_b16 v[74:75], v162 offset:16896
    ds_read_b128 v[56:59], v160 offset:40960
    ds_read_b64_tr_b16 v[76:77], v162 offset:24576
    ds_read_b64_tr_b16 v[78:79], v162 offset:25088
    ds_read_b128 v[60:63], v160 offset:43008
    ds_read_b128 v[64:67], v160 offset:45056
    ds_read_b128 v[68:71], v154 offset:0
    s_waitcnt lgkmcnt(5)
    v_mfma_f32_16x16x32_bf16 v[24:27], v[56:59], v[72:75], v[80:83]
    ds_read_b64_tr_b16 v[128:129], v162 offset:20480
    ds_read_b64_tr_b16 v[130:131], v162 offset:20992
    s_waitcnt lgkmcnt(5)
    v_mfma_f32_16x16x32_bf16 v[136:139], v[56:59], v[76:79], 0
    ds_read_b128 v[112:115], v161 offset:40960
    s_waitcnt lgkmcnt(5)
    v_mfma_f32_16x16x32_bf16 v[28:31], v[60:63], v[72:75], v[80:83]
    v_mfma_f32_16x16x32_bf16 v[140:143], v[60:63], v[76:79], 0
    ds_read_b64_tr_b16 v[132:133], v162 offset:28672
    s_waitcnt lgkmcnt(5)
    v_mfma_f32_16x16x32_bf16 v[32:35], v[64:67], v[72:75], v[80:83]
    v_mfma_f32_16x16x32_bf16 v[144:147], v[64:67], v[76:79], 0
    ds_read_b64_tr_b16 v[134:135], v162 offset:29184
    s_waitcnt lgkmcnt(5)
    v_mfma_f32_16x16x32_bf16 v[36:39], v[68:71], v[72:75], v[80:83]
    v_mfma_f32_16x16x32_bf16 v[148:151], v[68:71], v[76:79], 0
    ds_read_b128 v[116:119], v161 offset:43008
    ds_read_b128 v[120:123], v161 offset:45056
    ds_read_b128 v[124:127], v155 offset:0
    s_waitcnt lgkmcnt(5)
    v_mfma_f32_16x16x32_bf16 v[24:27], v[112:115], v[128:131], v[24:27]
    s_waitcnt lgkmcnt(3)
    v_mfma_f32_16x16x32_bf16 v[136:139], v[112:115], v[132:135], v[136:139]
    s_waitcnt lgkmcnt(2)
    v_mfma_f32_16x16x32_bf16 v[28:31], v[116:119], v[128:131], v[28:31]
    v_mfma_f32_16x16x32_bf16 v[140:143], v[116:119], v[132:135], v[140:143]
    s_waitcnt lgkmcnt(0)
    s_barrier
    ds_read_b64_tr_b16 v[72:73], v157 offset:16384
    ds_read_b64_tr_b16 v[74:75], v157 offset:16896
    v_mfma_f32_16x16x32_bf16 v[32:35], v[120:123], v[128:131], v[32:35]
    ds_read_b128 v[56:59], v158 offset:0
    ds_read_b64_tr_b16 v[76:77], v157 offset:24576
    v_mfma_f32_16x16x32_bf16 v[144:147], v[120:123], v[132:135], v[144:147]
    ds_read_b64_tr_b16 v[78:79], v157 offset:25088
    ds_read_b128 v[60:63], v158 offset:2048
    v_mfma_f32_16x16x32_bf16 v[36:39], v[124:127], v[128:131], v[36:39]
    ds_read_b128 v[64:67], v158 offset:4096
    ds_read_b128 v[68:71], v154 offset:4096
    v_mfma_f32_16x16x32_bf16 v[148:151], v[124:127], v[132:135], v[148:151]
    s_waitcnt lgkmcnt(5)
    v_mfma_f32_16x16x32_bf16 v[24:27], v[56:59], v[72:75], v[24:27]
    ds_read_b64_tr_b16 v[128:129], v157 offset:20480
    ds_read_b64_tr_b16 v[130:131], v157 offset:20992
    s_waitcnt lgkmcnt(5)
    v_mfma_f32_16x16x32_bf16 v[136:139], v[56:59], v[76:79], v[136:139]
    ds_read_b128 v[112:115], v159 offset:0
    s_waitcnt lgkmcnt(5)
    v_mfma_f32_16x16x32_bf16 v[28:31], v[60:63], v[72:75], v[28:31]
    v_mfma_f32_16x16x32_bf16 v[140:143], v[60:63], v[76:79], v[140:143]
    ds_read_b64_tr_b16 v[132:133], v157 offset:28672
    s_waitcnt lgkmcnt(5)
    v_mfma_f32_16x16x32_bf16 v[32:35], v[64:67], v[72:75], v[32:35]
    v_mfma_f32_16x16x32_bf16 v[144:147], v[64:67], v[76:79], v[144:147]
    ds_read_b64_tr_b16 v[134:135], v157 offset:29184
    s_waitcnt lgkmcnt(5)
    v_mfma_f32_16x16x32_bf16 v[36:39], v[68:71], v[72:75], v[36:39]
    v_mfma_f32_16x16x32_bf16 v[148:151], v[68:71], v[76:79], v[148:151]
    ds_read_b128 v[116:119], v159 offset:2048
    ds_read_b128 v[120:123], v159 offset:4096
    ds_read_b128 v[124:127], v155 offset:4096
    s_waitcnt lgkmcnt(5)
    v_mfma_f32_16x16x32_bf16 v[24:27], v[112:115], v[128:131], v[24:27]
    s_waitcnt lgkmcnt(3)
    v_mfma_f32_16x16x32_bf16 v[136:139], v[112:115], v[132:135], v[136:139]
    s_waitcnt lgkmcnt(2)
    v_mfma_f32_16x16x32_bf16 v[28:31], v[116:119], v[128:131], v[28:31]
    v_mfma_f32_16x16x32_bf16 v[140:143], v[116:119], v[132:135], v[140:143]
    s_waitcnt lgkmcnt(0)
    s_barrier
    ds_read_b64_tr_b16 v[72:73], v156 offset:16384
    ds_read_b64_tr_b16 v[74:75], v156 offset:16896
    v_mfma_f32_16x16x32_bf16 v[32:35], v[120:123], v[128:131], v[32:35]
    ds_read_b128 v[56:59], v160 offset:0
    ds_read_b64_tr_b16 v[76:77], v156 offset:24576
    v_mfma_f32_16x16x32_bf16 v[144:147], v[120:123], v[132:135], v[144:147]
    ds_read_b64_tr_b16 v[78:79], v156 offset:25088
    ds_read_b128 v[60:63], v160 offset:2048
    v_mfma_f32_16x16x32_bf16 v[36:39], v[124:127], v[128:131], v[36:39]
    ds_read_b128 v[64:67], v160 offset:4096
    ds_read_b128 v[68:71], v154 offset:8192
    v_mfma_f32_16x16x32_bf16 v[148:151], v[124:127], v[132:135], v[148:151]
    s_waitcnt lgkmcnt(5)
    v_mfma_f32_16x16x32_bf16 v[24:27], v[56:59], v[72:75], v[24:27]
    ds_read_b64_tr_b16 v[128:129], v156 offset:20480
    ds_read_b64_tr_b16 v[130:131], v156 offset:20992
    s_waitcnt lgkmcnt(5)
    v_mfma_f32_16x16x32_bf16 v[136:139], v[56:59], v[76:79], v[136:139]
    ds_read_b128 v[112:115], v161 offset:0
    s_waitcnt lgkmcnt(5)
    v_mfma_f32_16x16x32_bf16 v[28:31], v[60:63], v[72:75], v[28:31]
    v_mfma_f32_16x16x32_bf16 v[140:143], v[60:63], v[76:79], v[140:143]
    ds_read_b64_tr_b16 v[132:133], v156 offset:28672
    s_waitcnt lgkmcnt(5)
    v_mfma_f32_16x16x32_bf16 v[32:35], v[64:67], v[72:75], v[32:35]
    v_mfma_f32_16x16x32_bf16 v[144:147], v[64:67], v[76:79], v[144:147]
    ds_read_b64_tr_b16 v[134:135], v156 offset:29184
    s_waitcnt lgkmcnt(5)
    v_mfma_f32_16x16x32_bf16 v[36:39], v[68:71], v[72:75], v[36:39]
    v_mfma_f32_16x16x32_bf16 v[148:151], v[68:71], v[76:79], v[148:151]
    ds_read_b128 v[116:119], v161 offset:2048
    ds_read_b128 v[120:123], v161 offset:4096
    ds_read_b128 v[124:127], v155 offset:8192
    s_waitcnt lgkmcnt(5)
    v_mfma_f32_16x16x32_bf16 v[24:27], v[112:115], v[128:131], v[24:27]
    s_waitcnt lgkmcnt(3)
    v_mfma_f32_16x16x32_bf16 v[136:139], v[112:115], v[132:135], v[136:139]
    s_waitcnt lgkmcnt(2)
    v_mfma_f32_16x16x32_bf16 v[28:31], v[116:119], v[128:131], v[28:31]
    v_mfma_f32_16x16x32_bf16 v[140:143], v[116:119], v[132:135], v[140:143]
    s_waitcnt lgkmcnt(0)
    s_barrier
    ds_read_b64_tr_b16 v[72:73], v162 offset:16384
    ds_read_b64_tr_b16 v[74:75], v162 offset:16896
    v_mfma_f32_16x16x32_bf16 v[32:35], v[120:123], v[128:131], v[32:35]
    ds_read_b128 v[56:59], v160 offset:40960
    ds_read_b64_tr_b16 v[76:77], v162 offset:24576
    v_mfma_f32_16x16x32_bf16 v[144:147], v[120:123], v[132:135], v[144:147]
    ds_read_b64_tr_b16 v[78:79], v162 offset:25088
    ds_read_b128 v[60:63], v160 offset:43008
    v_mfma_f32_16x16x32_bf16 v[36:39], v[124:127], v[128:131], v[36:39]
    ds_read_b128 v[64:67], v160 offset:45056
    ds_read_b128 v[68:71], v154 offset:12288
    v_mfma_f32_16x16x32_bf16 v[148:151], v[124:127], v[132:135], v[148:151]
    s_waitcnt lgkmcnt(5)
    v_mfma_f32_16x16x32_bf16 v[24:27], v[56:59], v[72:75], v[24:27]
    ds_read_b64_tr_b16 v[128:129], v162 offset:20480
    ds_read_b64_tr_b16 v[130:131], v162 offset:20992
    s_waitcnt lgkmcnt(5)
    v_mfma_f32_16x16x32_bf16 v[136:139], v[56:59], v[76:79], v[136:139]
    ds_read_b128 v[112:115], v161 offset:40960
    s_waitcnt lgkmcnt(5)
    v_mfma_f32_16x16x32_bf16 v[28:31], v[60:63], v[72:75], v[28:31]
    v_mfma_f32_16x16x32_bf16 v[140:143], v[60:63], v[76:79], v[140:143]
    ds_read_b64_tr_b16 v[132:133], v162 offset:28672
    s_waitcnt lgkmcnt(5)
    v_mfma_f32_16x16x32_bf16 v[32:35], v[64:67], v[72:75], v[32:35]
    v_mfma_f32_16x16x32_bf16 v[144:147], v[64:67], v[76:79], v[144:147]
    ds_read_b64_tr_b16 v[134:135], v162 offset:29184
    s_waitcnt lgkmcnt(5)
    v_mfma_f32_16x16x32_bf16 v[36:39], v[68:71], v[72:75], v[36:39]
    v_mfma_f32_16x16x32_bf16 v[148:151], v[68:71], v[76:79], v[148:151]
    ds_read_b128 v[116:119], v161 offset:43008
    ds_read_b128 v[120:123], v161 offset:45056
    ds_read_b128 v[124:127], v155 offset:12288
    s_waitcnt lgkmcnt(5)
    v_mfma_f32_16x16x32_bf16 v[24:27], v[112:115], v[128:131], v[24:27]
    s_waitcnt lgkmcnt(3)
    v_mfma_f32_16x16x32_bf16 v[136:139], v[112:115], v[132:135], v[136:139]
    s_waitcnt lgkmcnt(2)
    v_mfma_f32_16x16x32_bf16 v[28:31], v[116:119], v[128:131], v[28:31]
    v_mfma_f32_16x16x32_bf16 v[140:143], v[116:119], v[132:135], v[140:143]
    s_waitcnt lgkmcnt(0)
    v_mov_b32_e64 v13, 1
    v_mov_b32 v12, 0x79000000
    s_barrier
    ds_read_b64_tr_b16 v[72:73], v157 offset:16384
    ds_read_b64_tr_b16 v[74:75], v157 offset:16896
    v_mfma_f32_16x16x32_bf16 v[32:35], v[120:123], v[128:131], v[32:35]
    ds_read_b128 v[56:59], v158 offset:0
    ds_read_b64_tr_b16 v[76:77], v157 offset:24576
    v_mfma_f32_16x16x32_bf16 v[144:147], v[120:123], v[132:135], v[144:147]
    ds_read_b64_tr_b16 v[78:79], v157 offset:25088
    ds_read_b128 v[60:63], v158 offset:2048
    v_mfma_f32_16x16x32_bf16 v[36:39], v[124:127], v[128:131], v[36:39]
    ds_read_b128 v[64:67], v158 offset:4096
    ds_read_b128 v[68:71], v154 offset:16384
    v_mfma_f32_16x16x32_bf16 v[148:151], v[124:127], v[132:135], v[148:151]
    s_waitcnt lgkmcnt(5)
    v_mfma_f32_16x16x32_bf16 v[24:27], v[56:59], v[72:75], v[24:27]
    ds_read_b64_tr_b16 v[128:129], v157 offset:20480
    ds_read_b64_tr_b16 v[130:131], v157 offset:20992
    s_waitcnt lgkmcnt(5)
    v_mfma_f32_16x16x32_bf16 v[136:139], v[56:59], v[76:79], v[136:139]
    ds_read_b128 v[112:115], v159 offset:0
    s_waitcnt lgkmcnt(5)
    v_mfma_f32_16x16x32_bf16 v[28:31], v[60:63], v[72:75], v[28:31]
    v_mfma_f32_16x16x32_bf16 v[140:143], v[60:63], v[76:79], v[140:143]
    ds_read_b64_tr_b16 v[132:133], v157 offset:28672
    s_waitcnt lgkmcnt(5)
    v_mfma_f32_16x16x32_bf16 v[32:35], v[64:67], v[72:75], v[32:35]
    v_mfma_f32_16x16x32_bf16 v[144:147], v[64:67], v[76:79], v[144:147]
    ds_read_b64_tr_b16 v[134:135], v157 offset:29184
    s_waitcnt lgkmcnt(5)
    v_mfma_f32_16x16x32_bf16 v[36:39], v[68:71], v[72:75], v[36:39]
    v_mfma_f32_16x16x32_bf16 v[148:151], v[68:71], v[76:79], v[148:151]
    ds_read_b128 v[116:119], v159 offset:2048
    ds_read_b128 v[120:123], v159 offset:4096
    ds_read_b128 v[124:127], v155 offset:16384
    s_waitcnt lgkmcnt(5)
    v_mfma_f32_16x16x32_bf16 v[24:27], v[112:115], v[128:131], v[24:27]
    s_waitcnt lgkmcnt(3)
    v_mfma_f32_16x16x32_bf16 v[136:139], v[112:115], v[132:135], v[136:139]
    s_waitcnt lgkmcnt(2)
    v_mfma_f32_16x16x32_bf16 v[28:31], v[116:119], v[128:131], v[28:31]
    v_mfma_f32_16x16x32_bf16 v[140:143], v[116:119], v[132:135], v[140:143]
    s_waitcnt lgkmcnt(0)
    s_barrier
    ds_read_b64_tr_b16 v[72:73], v156 offset:16384
    ds_read_b64_tr_b16 v[74:75], v156 offset:16896
    v_mfma_f32_16x16x32_bf16 v[32:35], v[120:123], v[128:131], v[32:35]
    ds_read_b128 v[56:59], v160 offset:0
    ds_read_b64_tr_b16 v[76:77], v156 offset:24576
    v_mfma_f32_16x16x32_bf16 v[144:147], v[120:123], v[132:135], v[144:147]
    ds_read_b64_tr_b16 v[78:79], v156 offset:25088
    ds_read_b128 v[60:63], v160 offset:2048
    v_mfma_f32_16x16x32_bf16 v[36:39], v[124:127], v[128:131], v[36:39]
    ds_read_b128 v[64:67], v160 offset:4096
    ds_read_b128 v[68:71], v154 offset:20480
    v_mfma_f32_16x16x32_bf16 v[148:151], v[124:127], v[132:135], v[148:151]
    s_waitcnt lgkmcnt(5)
    v_mfma_f32_16x16x32_bf16 v[24:27], v[56:59], v[72:75], v[24:27]
    ds_read_b64_tr_b16 v[128:129], v156 offset:20480
    ds_read_b64_tr_b16 v[130:131], v156 offset:20992
    s_waitcnt lgkmcnt(5)
    v_mfma_f32_16x16x32_bf16 v[136:139], v[56:59], v[76:79], v[136:139]
    ds_read_b128 v[112:115], v161 offset:0
    s_waitcnt lgkmcnt(5)
    v_mfma_f32_16x16x32_bf16 v[28:31], v[60:63], v[72:75], v[28:31]
    v_mfma_f32_16x16x32_bf16 v[140:143], v[60:63], v[76:79], v[140:143]
    ds_read_b64_tr_b16 v[132:133], v156 offset:28672
    s_waitcnt lgkmcnt(5)
    v_mfma_f32_16x16x32_bf16 v[32:35], v[64:67], v[72:75], v[32:35]
    v_mfma_f32_16x16x32_bf16 v[144:147], v[64:67], v[76:79], v[144:147]
    ds_read_b64_tr_b16 v[134:135], v156 offset:29184
    s_waitcnt lgkmcnt(5)
    v_mfma_f32_16x16x32_bf16 v[36:39], v[68:71], v[72:75], v[36:39]
    v_mfma_f32_16x16x32_bf16 v[148:151], v[68:71], v[76:79], v[148:151]
    ds_read_b128 v[116:119], v161 offset:2048
    ds_read_b128 v[120:123], v161 offset:4096
    ds_read_b128 v[124:127], v155 offset:20480
    s_waitcnt lgkmcnt(5)
    v_mfma_f32_16x16x32_bf16 v[24:27], v[112:115], v[128:131], v[24:27]
    s_waitcnt lgkmcnt(3)
    v_mfma_f32_16x16x32_bf16 v[136:139], v[112:115], v[132:135], v[136:139]
    s_waitcnt lgkmcnt(2)
    v_mfma_f32_16x16x32_bf16 v[28:31], v[116:119], v[128:131], v[28:31]
    v_mfma_f32_16x16x32_bf16 v[140:143], v[116:119], v[132:135], v[140:143]
    s_waitcnt lgkmcnt(0)
    s_barrier
    ds_read_b64_tr_b16 v[72:73], v162 offset:16384
    ds_read_b64_tr_b16 v[74:75], v162 offset:16896
    v_mfma_f32_16x16x32_bf16 v[32:35], v[120:123], v[128:131], v[32:35]
    ds_read_b128 v[56:59], v160 offset:40960
    ds_read_b64_tr_b16 v[76:77], v162 offset:24576
    v_mfma_f32_16x16x32_bf16 v[144:147], v[120:123], v[132:135], v[144:147]
    ds_read_b64_tr_b16 v[78:79], v162 offset:25088
    ds_read_b128 v[60:63], v160 offset:43008
    v_mfma_f32_16x16x32_bf16 v[36:39], v[124:127], v[128:131], v[36:39]
    ds_read_b128 v[64:67], v160 offset:45056
    ds_read_b128 v[68:71], v154 offset:24576
    v_mfma_f32_16x16x32_bf16 v[148:151], v[124:127], v[132:135], v[148:151]
    s_waitcnt lgkmcnt(5)
    v_mfma_f32_16x16x32_bf16 v[24:27], v[56:59], v[72:75], v[24:27]
    ds_read_b64_tr_b16 v[128:129], v162 offset:20480
    ds_read_b64_tr_b16 v[130:131], v162 offset:20992
    s_waitcnt lgkmcnt(5)
    v_mfma_f32_16x16x32_bf16 v[136:139], v[56:59], v[76:79], v[136:139]
    ds_read_b128 v[112:115], v161 offset:40960
    s_waitcnt lgkmcnt(5)
    v_mfma_f32_16x16x32_bf16 v[28:31], v[60:63], v[72:75], v[28:31]
    v_mfma_f32_16x16x32_bf16 v[140:143], v[60:63], v[76:79], v[140:143]
    ds_read_b64_tr_b16 v[132:133], v162 offset:28672
    s_waitcnt lgkmcnt(5)
    v_mfma_f32_16x16x32_bf16 v[32:35], v[64:67], v[72:75], v[32:35]
    v_mfma_f32_16x16x32_bf16 v[144:147], v[64:67], v[76:79], v[144:147]
    ds_read_b64_tr_b16 v[134:135], v162 offset:29184
    s_waitcnt lgkmcnt(5)
    v_mfma_f32_16x16x32_bf16 v[36:39], v[68:71], v[72:75], v[36:39]
    v_mfma_f32_16x16x32_bf16 v[148:151], v[68:71], v[76:79], v[148:151]
    ds_read_b128 v[116:119], v161 offset:43008
    ds_read_b128 v[120:123], v161 offset:45056
    ds_read_b128 v[124:127], v155 offset:24576
    s_waitcnt lgkmcnt(5)
    v_mfma_f32_16x16x32_bf16 v[24:27], v[112:115], v[128:131], v[24:27]
    s_waitcnt lgkmcnt(3)
    v_mfma_f32_16x16x32_bf16 v[136:139], v[112:115], v[132:135], v[136:139]
    s_waitcnt lgkmcnt(2)
    v_mfma_f32_16x16x32_bf16 v[28:31], v[116:119], v[128:131], v[28:31]
    v_mfma_f32_16x16x32_bf16 v[140:143], v[116:119], v[132:135], v[140:143]
    s_waitcnt lgkmcnt(0)
    s_setprio 1
    s_barrier
    ds_read_b64_tr_b16 v[72:73], v157 offset:16384
    ds_read_b64_tr_b16 v[74:75], v157 offset:16896
    v_mfma_f32_16x16x32_bf16 v[32:35], v[120:123], v[128:131], v[32:35]
    ds_read_b128 v[56:59], v158 offset:0
    ds_read_b64_tr_b16 v[76:77], v157 offset:24576
    v_mfma_f32_16x16x32_bf16 v[144:147], v[120:123], v[132:135], v[144:147]
    ds_read_b64_tr_b16 v[78:79], v157 offset:25088
    ds_read_b128 v[60:63], v158 offset:2048
    v_mfma_f32_16x16x32_bf16 v[36:39], v[124:127], v[128:131], v[36:39]
    ds_read_b128 v[64:67], v158 offset:4096
    ds_read_b128 v[68:71], v154 offset:28672
    v_mfma_f32_16x16x32_bf16 v[148:151], v[124:127], v[132:135], v[148:151]
    s_waitcnt lgkmcnt(5)
    v_mfma_f32_16x16x32_bf16 v[24:27], v[56:59], v[72:75], v[24:27]
    ds_read_b64_tr_b16 v[128:129], v157 offset:20480
    ds_read_b64_tr_b16 v[130:131], v157 offset:20992
    s_waitcnt lgkmcnt(5)
    v_mfma_f32_16x16x32_bf16 v[136:139], v[56:59], v[76:79], v[136:139]
    ds_read_b128 v[112:115], v159 offset:0
    s_waitcnt lgkmcnt(5)
    v_mfma_f32_16x16x32_bf16 v[28:31], v[60:63], v[72:75], v[28:31]
    v_mfma_f32_16x16x32_bf16 v[140:143], v[60:63], v[76:79], v[140:143]
    ds_read_b64_tr_b16 v[132:133], v157 offset:28672
    s_waitcnt lgkmcnt(5)
    v_mfma_f32_16x16x32_bf16 v[32:35], v[64:67], v[72:75], v[32:35]
    v_mfma_f32_16x16x32_bf16 v[144:147], v[64:67], v[76:79], v[144:147]
    ds_read_b64_tr_b16 v[134:135], v157 offset:29184
    s_waitcnt lgkmcnt(5)
    v_mfma_f32_16x16x32_bf16 v[36:39], v[68:71], v[72:75], v[36:39]
    v_mfma_f32_16x16x32_bf16 v[148:151], v[68:71], v[76:79], v[148:151]
    ds_read_b128 v[116:119], v159 offset:2048
    ds_read_b128 v[120:123], v159 offset:4096
    ds_read_b128 v[124:127], v155 offset:28672
    s_waitcnt lgkmcnt(5)
    v_mfma_f32_16x16x32_bf16 v[24:27], v[112:115], v[128:131], v[24:27]
    s_waitcnt lgkmcnt(3)
    v_mfma_f32_16x16x32_bf16 v[136:139], v[112:115], v[132:135], v[136:139]
    s_waitcnt lgkmcnt(2)
    v_mfma_f32_16x16x32_bf16 v[28:31], v[116:119], v[128:131], v[28:31]
    v_mfma_f32_16x16x32_bf16 v[140:143], v[116:119], v[132:135], v[140:143]
    s_waitcnt lgkmcnt(1)
    v_mfma_f32_16x16x32_bf16 v[32:35], v[120:123], v[128:131], v[32:35]
    v_mfma_f32_16x16x32_bf16 v[144:147], v[120:123], v[132:135], v[144:147]
    s_waitcnt lgkmcnt(0)
    v_mfma_f32_16x16x32_bf16 v[36:39], v[124:127], v[128:131], v[36:39]
    v_mfma_f32_16x16x32_bf16 v[148:151], v[124:127], v[132:135], v[148:151]
    s_nop 0
    v_pk_fma_f32 v[124:125], v[24:25], s[96:97], v[152:153]
    v_pk_fma_f32 v[126:127], v[26:27], s[96:97], v[152:153]
    v_pk_fma_f32 v[128:129], v[28:29], s[96:97], v[152:153]
    v_pk_fma_f32 v[130:131], v[30:31], s[96:97], v[152:153]
    v_exp_f32 v124, v124 clamp
    v_exp_f32 v125, v125 clamp
    v_exp_f32 v126, v126 clamp
    v_exp_f32 v127, v127 clamp
    v_exp_f32 v128, v128 clamp
    v_exp_f32 v129, v129 clamp
    v_exp_f32 v130, v130 clamp
    v_exp_f32 v131, v131 clamp
    v_max_f32 v24, v24, v80
    v_max_f32 v25, v25, v80
    v_max_f32 v26, v26, v80
    v_max_f32 v27, v27, v80
    v_max_f32 v28, v28, v80
    v_max_f32 v29, v29, v80
    v_max_f32 v30, v30, v80
    v_max_f32 v31, v31, v80
    v_pk_add_f32 v[24:25], v[24:25], v[124:125]
    v_pk_add_f32 v[26:27], v[26:27], v[126:127]
    v_pk_add_f32 v[28:29], v[28:29], v[128:129]
    v_pk_add_f32 v[30:31], v[30:31], v[130:131]
    v_cvt_pk_bf16_f32 v116, v24, v25
    v_cvt_pk_bf16_f32 v117, v26, v27
    v_cvt_pk_bf16_f32 v118, v28, v29
    v_cvt_pk_bf16_f32 v119, v30, v31
    v_cvt_pk_bf16_f32 v136, v136, v137
    v_cvt_pk_bf16_f32 v137, v138, v139
    v_cvt_pk_bf16_f32 v138, v140, v141
    v_cvt_pk_bf16_f32 v139, v142, v143
    v_pk_fma_f32 v[124:125], v[32:33], s[96:97], v[152:153]
    v_pk_fma_f32 v[126:127], v[34:35], s[96:97], v[152:153]
    v_pk_fma_f32 v[128:129], v[36:37], s[96:97], v[152:153]
    v_pk_fma_f32 v[130:131], v[38:39], s[96:97], v[152:153]
    s_barrier
    s_setprio 2
    ds_read_b128 v[16:19], v8
    ds_read_b128 v[112:115], v1 offset:0
    v_mfma_f32_16x16x32_bf16 v[76:79], v[116:119], v[84:87], 0
    v_exp_f32 v124, v124 clamp
    v_mfma_f32_16x16x32_bf16 v[72:75], v[116:119], v[136:139], 0
    v_exp_f32 v125, v125 clamp
    v_exp_f32 v126, v126 clamp
    v_exp_f32 v127, v127 clamp
    v_exp_f32 v128, v128 clamp
    v_exp_f32 v129, v129 clamp
    v_exp_f32 v130, v130 clamp
    v_exp_f32 v131, v131 clamp
    s_waitcnt lgkmcnt(0)
    v_mfma_f32_32x32x16_bf16 v[56:71], v[112:115], v[16:19], 0
    v_max_f32 v32, v32, v80
    v_max_f32 v33, v33, v80
    v_max_f32 v34, v34, v80
    v_max_f32 v35, v35, v80
    v_max_f32 v36, v36, v80
    v_max_f32 v37, v37, v80
    v_max_f32 v38, v38, v80
    v_max_f32 v39, v39, v80
    v_add_f32 v32, v32, v124
    v_add_f32 v33, v33, v125
    v_add_f32 v34, v34, v126
    v_add_f32 v35, v35, v127
    v_add_f32 v36, v36, v128
    v_add_f32 v37, v37, v129
    v_add_f32 v38, v38, v130
    v_add_f32_e64 v39, v39, v131
    v_cvt_pk_bf16_f32 v120, v32, v33
    v_cvt_pk_bf16_f32 v121, v34, v35
    v_cvt_pk_bf16_f32 v122, v36, v37
    v_cvt_pk_bf16_f32 v123, v38, v39
    v_cvt_pk_bf16_f32 v144, v144, v145
    v_cvt_pk_bf16_f32 v145, v146, v147
    v_cvt_pk_bf16_f32 v146, v148, v149
    v_cvt_pk_bf16_f32 v147, v150, v151
    v_mfma_f32_16x16x32_bf16 v[76:79], v[120:123], v[84:87], v[76:79]
    v_max3_f32 v10, v56, v57, v58
    v_max3_f32 v11, v59, v60, v61
    v_max3_f32 v10, v10, v62, v63
    v_max3_f32 v11, v11, v64, v65
    v_max3_f32 v10, v10, v66, v67
    v_max3_f32 v11, v11, v68, v69
    v_max3_f32 v10, v10, v70, v71
    v_mfma_f32_16x16x32_bf16 v[72:75], v[120:123], v[144:147], v[72:75]
    v_max_f32 v10, v10, v11
    v_mov_b32 v11, v10
    s_nop 1
    v_permlane32_swap_b32 v10, v11
    v_max_f32 v10, v10, v11
    v_sub_f32 v24, 0xc2c80000, v10
    v_ceil_f32 v24, v24
    v_mov_b32 v25, v24
    v_mov_b64 v[26:27], v[24:25]
    v_mov_b64 v[28:29], v[24:25]
    v_mov_b64 v[30:31], v[24:25]
    v_mov_b64 v[32:33], v[24:25]
    v_mov_b64 v[34:35], v[24:25]
    v_mov_b64 v[36:37], v[24:25]
    v_mov_b64 v[38:39], v[24:25]
    ds_read_b128 v[88:91], v1 offset:2048
    ds_read_b128 v[92:95], v1 offset:4096
    v_mfma_f32_32x32x16_bf16 v[56:71], v[112:115], v[16:19], v[24:39]
    s_mov_b64 exec, s[80:81]
    ds_read_b128 v[96:99], v1 offset:1024
    ds_read_b128 v[108:111], v1 offset:1280
    ds_read_b128 v[104:107], v1 offset:3072
    s_mov_b64 exec, -1
    ds_write_b128 v165, v[72:75]
    s_mov_b32 exec_lo, 0x00010001
    s_mov_b32 exec_hi, 0x00010001
    ds_write_b128 v165, v[76:79] offset:512
    s_mov_b64 exec, 1
    s_waitcnt lgkmcnt(0)
    ds_add_u32 v163, v13 offset:28
    s_mov_b64 exec, -1
L_att:
    s_setprio 0
    v_exp_f32 v56, v56
    s_setprio 1
    v_exp_f32 v57, v57
    v_exp_f32 v58, v58
    v_exp_f32 v59, v59
    v_exp_f32 v60, v60
    v_mfma_f32_32x32x16_bf16 v[72:87], v[88:91], v[16:19], v[24:39]
    v_exp_f32 v61, v61
    v_exp_f32 v62, v62
    v_exp_f32 v63, v63
    v_exp_f32 v64, v64
    v_exp_f32 v65, v65
    v_smfmac_f32_32x32x32_bf16 v[40:55], v[96:99], v[56:63], v3
    v_exp_f32 v66, v66
    v_exp_f32 v67, v67
    v_exp_f32 v68, v68
    v_exp_f32 v69, v69
    v_exp_f32 v70, v70
    v_exp_f32 v71, v71
    v_exp_f32 v72, v72
    v_exp_f32 v73, v73
    v_smfmac_f32_32x32x32_bf16 v[40:55], v[108:111], v[64:71], v3
    v_exp_f32 v74, v74
    v_exp_f32 v75, v75
    v_exp_f32 v76, v76
    v_mfma_f32_32x32x16_bf16 v[56:71], v[92:95], v[16:19], v[24:39]
    v_exp_f32 v77, v77
    v_exp_f32 v78, v78
    v_exp_f32 v79, v79
    v_exp_f32 v80, v80
    v_exp_f32 v81, v81
    v_smfmac_f32_32x32x32_bf16 v[40:55], v[104:107], v[72:79], v3
    v_exp_f32 v82, v82
    v_exp_f32 v83, v83
    v_exp_f32 v84, v84
    v_exp_f32 v85, v85
    v_exp_f32 v86, v86
    s_setprio 2
    v_exp_f32 v87, v87
    s_setprio 0
    s_mov_b64 exec, s[80:81]
    ds_read_b128 v[100:103], v1 offset:3328
    ds_read_b128 v[96:99], v1 offset:5120
    ds_read_b128 v[108:111], v1 offset:5376
    ds_read_b128 v[104:107], v1 offset:7168
    s_mov_b64 exec, -1
    ds_read_b128 v[88:91], v1 offset:6144
    ds_read_b128 v[92:95], v1 offset:8192
    s_waitcnt lgkmcnt(0)
    v_exp_f32 v56, v56
    s_setprio 1
    v_exp_f32 v57, v57
    v_smfmac_f32_32x32x32_bf16 v[40:55], v[100:103], v[80:87], v3
    v_exp_f32 v58, v58
    v_exp_f32 v59, v59
    v_exp_f32 v60, v60
    v_mfma_f32_32x32x16_bf16 v[72:87], v[88:91], v[16:19], v[24:39]
    v_exp_f32 v61, v61
    v_exp_f32 v62, v62
    v_exp_f32 v63, v63
    v_exp_f32 v64, v64
    v_exp_f32 v65, v65
    v_smfmac_f32_32x32x32_bf16 v[40:55], v[96:99], v[56:63], v3
    v_exp_f32 v66, v66
    v_exp_f32 v67, v67
    v_exp_f32 v68, v68
    v_exp_f32 v69, v69
    v_exp_f32 v70, v70
    v_exp_f32 v71, v71
    v_exp_f32 v72, v72
    v_exp_f32 v73, v73
    v_smfmac_f32_32x32x32_bf16 v[40:55], v[108:111], v[64:71], v3
    v_exp_f32 v74, v74
    v_exp_f32 v75, v75
    v_exp_f32 v76, v76
    v_mfma_f32_32x32x16_bf16 v[56:71], v[92:95], v[16:19], v[24:39]
    v_exp_f32 v77, v77
    v_exp_f32 v78, v78
    v_exp_f32 v79, v79
    v_exp_f32 v80, v80
    v_exp_f32 v81, v81
    v_smfmac_f32_32x32x32_bf16 v[40:55], v[104:107], v[72:79], v3
    v_exp_f32 v82, v82
    v_exp_f32 v83, v83
    v_exp_f32 v84, v84
    v_exp_f32 v85, v85
    v_exp_f32 v86, v86
    s_setprio 2
    v_exp_f32 v87, v87
    s_setprio 0
    s_mov_b64 exec, s[80:81]
    ds_read_b128 v[100:103], v1 offset:7424
    ds_read_b128 v[96:99], v1 offset:9216
    ds_read_b128 v[108:111], v1 offset:9472
    ds_read_b128 v[104:107], v1 offset:11264
    s_mov_b64 exec, -1
    ds_read_b128 v[88:91], v1 offset:10240
    ds_read_b128 v[92:95], v1 offset:12288
    s_waitcnt lgkmcnt(0)
    v_exp_f32 v56, v56
    s_setprio 1
    v_exp_f32 v57, v57
    v_smfmac_f32_32x32x32_bf16 v[40:55], v[100:103], v[80:87], v3
    v_exp_f32 v58, v58
    v_exp_f32 v59, v59
    v_exp_f32 v60, v60
    v_mfma_f32_32x32x16_bf16 v[72:87], v[88:91], v[16:19], v[24:39]
    v_exp_f32 v61, v61
    v_exp_f32 v62, v62
    v_exp_f32 v63, v63
    v_exp_f32 v64, v64
    v_exp_f32 v65, v65
    v_smfmac_f32_32x32x32_bf16 v[40:55], v[96:99], v[56:63], v3
    v_exp_f32 v66, v66
    v_exp_f32 v67, v67
    v_exp_f32 v68, v68
    v_exp_f32 v69, v69
    v_exp_f32 v70, v70
    v_exp_f32 v71, v71
    v_exp_f32 v72, v72
    v_exp_f32 v73, v73
    v_smfmac_f32_32x32x32_bf16 v[40:55], v[108:111], v[64:71], v3
    v_exp_f32 v74, v74
    v_exp_f32 v75, v75
    v_exp_f32 v76, v76
    v_mfma_f32_32x32x16_bf16 v[56:71], v[92:95], v[16:19], v[24:39]
    v_exp_f32 v77, v77
    v_exp_f32 v78, v78
    v_exp_f32 v79, v79
    v_exp_f32 v80, v80
    v_exp_f32 v81, v81
    v_smfmac_f32_32x32x32_bf16 v[40:55], v[104:107], v[72:79], v3
    v_exp_f32 v82, v82
    v_exp_f32 v83, v83
    v_exp_f32 v84, v84
    v_exp_f32 v85, v85
    v_exp_f32 v86, v86
    s_setprio 2
    v_exp_f32 v87, v87
    s_setprio 0
    s_mov_b64 exec, s[80:81]
    ds_read_b128 v[100:103], v1 offset:11520
    ds_read_b128 v[96:99], v1 offset:13312
    ds_read_b128 v[108:111], v1 offset:13568
    ds_read_b128 v[104:107], v1 offset:15360
    s_mov_b64 exec, -1
    ds_read_b128 v[88:91], v1 offset:14336
    ds_read_b128 v[92:95], v1 offset:16384
    s_waitcnt lgkmcnt(0)
    v_exp_f32 v56, v56
    s_setprio 1
    v_exp_f32 v57, v57
    v_smfmac_f32_32x32x32_bf16 v[40:55], v[100:103], v[80:87], v3
    v_exp_f32 v58, v58
    v_exp_f32 v59, v59
    v_exp_f32 v60, v60
    v_mfma_f32_32x32x16_bf16 v[72:87], v[88:91], v[16:19], v[24:39]
    v_exp_f32 v61, v61
    v_exp_f32 v62, v62
    v_exp_f32 v63, v63
    v_exp_f32 v64, v64
    v_exp_f32 v65, v65
    v_smfmac_f32_32x32x32_bf16 v[40:55], v[96:99], v[56:63], v3
    v_exp_f32 v66, v66
    v_exp_f32 v67, v67
    v_exp_f32 v68, v68
    v_exp_f32 v69, v69
    v_exp_f32 v70, v70
    v_exp_f32 v71, v71
    v_exp_f32 v72, v72
    v_exp_f32 v73, v73
    v_smfmac_f32_32x32x32_bf16 v[40:55], v[108:111], v[64:71], v3
    v_exp_f32 v74, v74
    v_exp_f32 v75, v75
    v_exp_f32 v76, v76
    v_mfma_f32_32x32x16_bf16 v[56:71], v[92:95], v[16:19], v[24:39]
    v_exp_f32 v77, v77
    v_exp_f32 v78, v78
    v_exp_f32 v79, v79
    v_exp_f32 v80, v80
    v_exp_f32 v81, v81
    v_smfmac_f32_32x32x32_bf16 v[40:55], v[104:107], v[72:79], v3
    v_exp_f32 v82, v82
    v_exp_f32 v83, v83
    v_exp_f32 v84, v84
    v_exp_f32 v85, v85
    v_exp_f32 v86, v86
    s_setprio 3
    v_exp_f32 v87, v87
    s_setprio 0
    s_mov_b64 exec, s[80:81]
    ds_read_b128 v[100:103], v1 offset:15616
    ds_read_b128 v[96:99], v1 offset:17408
    ds_read_b128 v[108:111], v1 offset:17664
    ds_read_b128 v[104:107], v1 offset:19456
    s_mov_b64 exec, -1
    ds_read_b128 v[88:91], v1 offset:18432
    ds_read_b128 v[92:95], v1 offset:20480
    s_waitcnt lgkmcnt(0)
    v_exp_f32 v56, v56
    s_setprio 2
    v_frexp_exp_i32_f32 v10, v48
    v_sub_u32 v10, -99, v10
    v_max_i32 v10, 0xffffff88, v10
    v_cvt_f32_i32 v11, v10
    v_add_f32 v24, v24, v11
    v_ldexp_f32 v10, 1.0, v10
    v_mov_b32 v25, v24
    v_mov_b64 v[26:27], v[24:25]
    v_mov_b64 v[28:29], v[24:25]
    v_mov_b64 v[30:31], v[24:25]
    v_mov_b64 v[32:33], v[24:25]
    v_mov_b64 v[34:35], v[24:25]
    v_mov_b64 v[36:37], v[24:25]
    v_mov_b64 v[38:39], v[24:25]
    v_exp_f32 v57, v57
    v_smfmac_f32_32x32x32_bf16 v[40:55], v[100:103], v[80:87], v3
    v_exp_f32 v58, v58
    v_exp_f32 v59, v59
    v_exp_f32 v60, v60
    v_mfma_f32_32x32x16_bf16 v[72:87], v[88:91], v[16:19], v[24:39]
    v_exp_f32 v61, v61
    v_exp_f32 v62, v62
    v_exp_f32 v63, v63
    v_exp_f32 v64, v64
    v_exp_f32 v65, v65
    v_smfmac_f32_32x32x32_bf16 v[40:55], v[96:99], v[56:63], v3
    v_exp_f32 v66, v66
    v_exp_f32 v67, v67
    v_exp_f32 v68, v68
    v_exp_f32 v69, v69
    v_exp_f32 v70, v70
    v_exp_f32 v71, v71
    v_exp_f32 v72, v72
    v_exp_f32 v73, v73
    v_smfmac_f32_32x32x32_bf16 v[40:55], v[108:111], v[64:71], v3
    v_exp_f32 v74, v74
    v_exp_f32 v75, v75
    v_exp_f32 v76, v76
    v_mfma_f32_32x32x16_bf16 v[56:71], v[92:95], v[16:19], v[24:39]
    v_exp_f32 v77, v77
    v_exp_f32 v78, v78
    v_exp_f32 v79, v79
    v_exp_f32 v80, v80
    v_exp_f32 v81, v81
    v_exp_f32 v82, v82
    v_exp_f32 v83, v83
    v_exp_f32_e64 v84, v84
    v_pk_mul_f32 v[40:41], v[40:41], v[10:11] op_sel_hi:[1,0]
    v_pk_mul_f32 v[42:43], v[42:43], v[10:11] op_sel_hi:[1,0]
    v_pk_mul_f32 v[44:45], v[44:45], v[10:11] op_sel_hi:[1,0]
    v_pk_mul_f32 v[46:47], v[46:47], v[10:11] op_sel_hi:[1,0]
    v_pk_mul_f32 v[48:49], v[48:49], v[10:11] op_sel_hi:[1,0]
    v_exp_f32 v85, v85
    v_exp_f32 v86, v86
    v_smfmac_f32_32x32x32_bf16 v[40:55], v[104:107], v[72:79], v3
    s_setprio 3
    v_exp_f32 v87, v87
    s_setprio 0
    s_mov_b64 exec, s[80:81]
    ds_read_b128 v[100:103], v1 offset:19712
    ds_read_b128 v[96:99], v1 offset:21504
    ds_read_b128 v[108:111], v1 offset:21760
    ds_read_b128 v[104:107], v1 offset:23552
    s_mov_b64 exec, -1
    ds_read_b128 v[88:91], v1 offset:22528
    ds_read_b128 v[92:95], v1 offset:24576
    s_waitcnt lgkmcnt(0)
    v_exp_f32 v56, v56
    s_setprio 1
    v_exp_f32 v57, v57
    v_smfmac_f32_32x32x32_bf16 v[40:55], v[100:103], v[80:87], v3
    v_exp_f32 v58, v58
    v_exp_f32 v59, v59
    v_exp_f32 v60, v60
    v_mfma_f32_32x32x16_bf16 v[72:87], v[88:91], v[16:19], v[24:39]
    v_exp_f32 v61, v61
    v_exp_f32 v62, v62
    v_exp_f32 v63, v63
    v_exp_f32 v64, v64
    v_exp_f32 v65, v65
    v_smfmac_f32_32x32x32_bf16 v[40:55], v[96:99], v[56:63], v3
    v_exp_f32 v66, v66
    v_exp_f32 v67, v67
    v_exp_f32 v68, v68
    v_exp_f32 v69, v69
    v_exp_f32 v70, v70
    v_exp_f32 v71, v71
    v_exp_f32 v72, v72
    v_exp_f32 v73, v73
    v_smfmac_f32_32x32x32_bf16 v[40:55], v[108:111], v[64:71], v3
    v_exp_f32 v74, v74
    v_exp_f32 v75, v75
    v_exp_f32 v76, v76
    v_mfma_f32_32x32x16_bf16 v[56:71], v[92:95], v[16:19], v[24:39]
    v_exp_f32 v77, v77
    v_exp_f32 v78, v78
    v_exp_f32 v79, v79
    v_exp_f32 v80, v80
    v_exp_f32 v81, v81
    v_smfmac_f32_32x32x32_bf16 v[40:55], v[104:107], v[72:79], v3
    v_exp_f32 v82, v82
    v_exp_f32 v83, v83
    v_exp_f32 v84, v84
    v_exp_f32 v85, v85
    v_exp_f32 v86, v86
    s_setprio 2
    v_exp_f32 v87, v87
    s_setprio 0
    s_mov_b64 exec, s[80:81]
    ds_read_b128 v[100:103], v1 offset:23808
    ds_read_b128 v[96:99], v1 offset:25600
    ds_read_b128 v[108:111], v1 offset:25856
    ds_read_b128 v[104:107], v1 offset:27648
    s_mov_b64 exec, -1
    ds_read_b128 v[88:91], v1 offset:26624
    ds_read_b128 v[92:95], v1 offset:28672
    ds_read_b32 v164, v163 offset:20
    s_waitcnt lgkmcnt(0)
    v_exp_f32 v56, v56
    s_setprio 1
    v_exp_f32 v57, v57
    v_smfmac_f32_32x32x32_bf16 v[40:55], v[100:103], v[80:87], v3
    v_exp_f32 v58, v58
    v_exp_f32 v59, v59
    v_exp_f32 v60, v60
    v_mfma_f32_32x32x16_bf16 v[72:87], v[88:91], v[16:19], v[24:39]
    v_exp_f32 v61, v61
    v_exp_f32 v62, v62
    v_exp_f32 v63, v63
    v_exp_f32 v64, v64
    v_exp_f32 v65, v65
    v_smfmac_f32_32x32x32_bf16 v[40:55], v[96:99], v[56:63], v3
    v_exp_f32 v66, v66
    v_exp_f32 v67, v67
    v_exp_f32 v68, v68
    v_exp_f32 v69, v69
    v_exp_f32 v70, v70
    v_exp_f32 v71, v71
    v_exp_f32 v72, v72
    v_exp_f32 v73, v73
    v_smfmac_f32_32x32x32_bf16 v[40:55], v[108:111], v[64:71], v3
    v_exp_f32 v74, v74
    v_exp_f32 v75, v75
    v_exp_f32 v76, v76
    v_mfma_f32_32x32x16_bf16 v[56:71], v[92:95], v[16:19], v[24:39]
    v_exp_f32 v77, v77
    v_exp_f32 v78, v78
    v_exp_f32 v79, v79
    v_exp_f32 v80, v80
    v_exp_f32 v81, v81
    v_smfmac_f32_32x32x32_bf16 v[40:55], v[104:107], v[72:79], v3
    v_exp_f32 v82, v82
    v_exp_f32 v83, v83
    v_exp_f32 v84, v84
    v_exp_f32 v85, v85
    v_exp_f32 v86, v86
    v_readfirstlane_b32 s73, v164
    s_setprio 2
    v_exp_f32_e64 v87, v87
    s_setprio 0
    s_cmp_lt_u32 s73, 4
    s_cbranch_scc1 L_spin_kv
L_ok_kv:
    s_cmp_eq_u32 s91, 0
    s_cbranch_scc1 L_havepq
    ds_read_b128 v[20:23], v8 offset:17920
L_havepq:
    s_mov_b64 exec, s[80:81]
    ds_read_b128 v[100:103], v1 offset:27904
    ds_read_b128 v[96:99], v1 offset:29696
    ds_read_b128 v[108:111], v1 offset:29952
    ds_read_b128 v[104:107], v1 offset:31744
    s_mov_b64 exec, -1
    ds_read_b128 v[88:91], v1 offset:30720
    ds_read_b128 v[92:95], v1 offset:32768
    s_waitcnt lgkmcnt(0)
    v_exp_f32 v56, v56
    s_setprio 1
    v_exp_f32 v57, v57
    v_smfmac_f32_32x32x32_bf16 v[40:55], v[100:103], v[80:87], v3
    v_exp_f32 v58, v58
    v_exp_f32 v59, v59
    v_exp_f32 v60, v60
    v_mfma_f32_32x32x16_bf16 v[72:87], v[88:91], v[16:19], v[24:39]
    v_exp_f32 v61, v61
    v_exp_f32 v62, v62
    v_exp_f32 v63, v63
    v_exp_f32 v64, v64
    v_exp_f32 v65, v65
    v_smfmac_f32_32x32x32_bf16 v[40:55], v[96:99], v[56:63], v3
    v_exp_f32 v66, v66
    v_exp_f32 v67, v67
    v_exp_f32 v68, v68
    v_exp_f32 v69, v69
    v_exp_f32 v70, v70
    v_exp_f32 v71, v71
    v_exp_f32 v72, v72
    v_exp_f32 v73, v73
    v_smfmac_f32_32x32x32_bf16 v[40:55], v[108:111], v[64:71], v3
    v_exp_f32 v74, v74
    v_exp_f32 v75, v75
    v_exp_f32 v76, v76
    v_mfma_f32_32x32x16_bf16 v[56:71], v[92:95], v[16:19], v[24:39]
    v_exp_f32 v77, v77
    v_exp_f32 v78, v78
    v_exp_f32 v79, v79
    v_exp_f32 v80, v80
    v_exp_f32 v81, v81
    v_smfmac_f32_32x32x32_bf16 v[40:55], v[104:107], v[72:79], v3
    v_exp_f32 v82, v82
    v_exp_f32 v83, v83
    v_exp_f32 v84, v84
    v_exp_f32 v85, v85
    v_exp_f32 v86, v86
    s_setprio 2
    v_exp_f32 v87, v87
    s_setprio 0
    s_mov_b64 exec, s[80:81]
    ds_read_b128 v[100:103], v1 offset:32000
    ds_read_b128 v[96:99], v1 offset:33792
    ds_read_b128 v[108:111], v1 offset:34048
    ds_read_b128 v[104:107], v1 offset:35840
    s_mov_b64 exec, -1
    ds_read_b128 v[88:91], v1 offset:34816
    ds_read_b128 v[92:95], v1 offset:36864
    s_waitcnt lgkmcnt(0)
    v_exp_f32 v56, v56
    s_setprio 1
    v_exp_f32 v57, v57
    v_smfmac_f32_32x32x32_bf16 v[40:55], v[100:103], v[80:87], v3
    v_exp_f32 v58, v58
    v_exp_f32 v59, v59
    v_exp_f32 v60, v60
    v_mfma_f32_32x32x16_bf16 v[72:87], v[88:91], v[16:19], v[24:39]
    v_exp_f32 v61, v61
    v_exp_f32 v62, v62
    v_exp_f32 v63, v63
    v_exp_f32 v64, v64
    v_exp_f32 v65, v65
    v_smfmac_f32_32x32x32_bf16 v[40:55], v[96:99], v[56:63], v3
    v_exp_f32 v66, v66
    v_exp_f32 v67, v67
    v_exp_f32 v68, v68
    v_exp_f32 v69, v69
    v_exp_f32 v70, v70
    v_exp_f32 v71, v71
    v_exp_f32 v72, v72
    v_exp_f32 v73, v73
    v_smfmac_f32_32x32x32_bf16 v[40:55], v[108:111], v[64:71], v3
    v_exp_f32 v74, v74
    v_exp_f32 v75, v75
    v_exp_f32 v76, v76
    v_mfma_f32_32x32x16_bf16 v[56:71], v[92:95], v[16:19], v[24:39]
    v_exp_f32 v77, v77
    v_exp_f32 v78, v78
    v_exp_f32 v79, v79
    v_exp_f32 v80, v80
    v_exp_f32 v81, v81
    v_smfmac_f32_32x32x32_bf16 v[40:55], v[104:107], v[72:79], v3
    v_exp_f32 v82, v82
    v_exp_f32 v83, v83
    v_exp_f32 v84, v84
    v_exp_f32 v85, v85
    v_exp_f32 v86, v86
    s_setprio 2
    v_exp_f32 v87, v87
    s_setprio 0
    s_mov_b64 exec, s[80:81]
    ds_read_b128 v[100:103], v1 offset:36096
    ds_read_b128 v[96:99], v1 offset:37888
    ds_read_b128 v[108:111], v1 offset:38144
    ds_read_b128 v[104:107], v1 offset:39936
    s_mov_b64 exec, -1
    ds_read_b128 v[88:91], v1 offset:38912
    ds_read_b128 v[92:95], v1 offset:40960
    s_waitcnt lgkmcnt(0)
    v_exp_f32 v56, v56
    s_setprio 1
    v_exp_f32 v57, v57
    v_smfmac_f32_32x32x32_bf16 v[40:55], v[100:103], v[80:87], v3
    v_exp_f32 v58, v58
    v_exp_f32 v59, v59
    v_exp_f32 v60, v60
    v_mfma_f32_32x32x16_bf16 v[72:87], v[88:91], v[16:19], v[24:39]
    v_exp_f32 v61, v61
    v_exp_f32 v62, v62
    v_exp_f32 v63, v63
    v_exp_f32 v64, v64
    v_exp_f32 v65, v65
    v_smfmac_f32_32x32x32_bf16 v[40:55], v[96:99], v[56:63], v3
    v_exp_f32 v66, v66
    v_exp_f32 v67, v67
    v_exp_f32 v68, v68
    v_exp_f32 v69, v69
    v_exp_f32 v70, v70
    v_exp_f32 v71, v71
    v_exp_f32 v72, v72
    v_exp_f32 v73, v73
    v_smfmac_f32_32x32x32_bf16 v[40:55], v[108:111], v[64:71], v3
    v_exp_f32 v74, v74
    v_exp_f32 v75, v75
    v_exp_f32 v76, v76
    v_mfma_f32_32x32x16_bf16 v[56:71], v[92:95], v[16:19], v[24:39]
    v_exp_f32 v77, v77
    v_exp_f32 v78, v78
    v_exp_f32 v79, v79
    v_exp_f32 v80, v80
    v_exp_f32 v81, v81
    v_smfmac_f32_32x32x32_bf16 v[40:55], v[104:107], v[72:79], v3
    v_exp_f32 v82, v82
    v_exp_f32 v83, v83
    v_exp_f32 v84, v84
    v_exp_f32 v85, v85
    v_exp_f32 v86, v86
    s_setprio 2
    v_exp_f32 v87, v87
    s_setprio 0
    s_mov_b64 exec, s[80:81]
    ds_read_b128 v[100:103], v1 offset:40192
    ds_read_b128 v[96:99], v1 offset:41984
    ds_read_b128 v[108:111], v1 offset:42240
    ds_read_b128 v[104:107], v1 offset:44032
    s_mov_b64 exec, -1
    ds_read_b128 v[88:91], v1 offset:43008
    ds_read_b128 v[92:95], v1 offset:45056
    s_waitcnt lgkmcnt(0)
    v_exp_f32 v56, v56
    s_setprio 1
    v_exp_f32 v57, v57
    v_smfmac_f32_32x32x32_bf16 v[40:55], v[100:103], v[80:87], v3
    v_exp_f32 v58, v58
    v_exp_f32 v59, v59
    v_exp_f32 v60, v60
    v_mfma_f32_32x32x16_bf16 v[72:87], v[88:91], v[16:19], v[24:39]
    v_exp_f32 v61, v61
    v_exp_f32 v62, v62
    v_exp_f32 v63, v63
    v_exp_f32 v64, v64
    v_exp_f32 v65, v65
    v_smfmac_f32_32x32x32_bf16 v[40:55], v[96:99], v[56:63], v3
    v_exp_f32 v66, v66
    v_exp_f32 v67, v67
    v_exp_f32 v68, v68
    v_exp_f32 v69, v69
    v_exp_f32 v70, v70
    v_exp_f32 v71, v71
    v_exp_f32 v72, v72
    v_exp_f32 v73, v73
    v_smfmac_f32_32x32x32_bf16 v[40:55], v[108:111], v[64:71], v3
    v_exp_f32 v74, v74
    v_exp_f32 v75, v75
    v_exp_f32 v76, v76
    v_mfma_f32_32x32x16_bf16 v[56:71], v[92:95], v[16:19], v[24:39]
    v_exp_f32 v77, v77
    v_exp_f32 v78, v78
    v_exp_f32 v79, v79
    v_exp_f32 v80, v80
    v_exp_f32 v81, v81
    v_smfmac_f32_32x32x32_bf16 v[40:55], v[104:107], v[72:79], v3
    v_exp_f32 v82, v82
    v_exp_f32 v83, v83
    v_exp_f32 v84, v84
    v_exp_f32 v85, v85
    v_exp_f32 v86, v86
    s_setprio 2
    v_exp_f32 v87, v87
    s_setprio 0
    s_mov_b64 exec, s[80:81]
    ds_read_b128 v[100:103], v1 offset:44288
    ds_read_b128 v[96:99], v1 offset:46080
    ds_read_b128 v[108:111], v1 offset:46336
    ds_read_b128 v[104:107], v1 offset:48128
    s_mov_b64 exec, -1
    ds_read_b128 v[88:91], v1 offset:47104
    ds_read_b128 v[92:95], v1 offset:49152
    buffer_load_dword v4, v167, s[44:47], 0 offen sc1
    s_waitcnt lgkmcnt(0)
    v_exp_f32 v56, v56
    s_setprio 1
    v_exp_f32 v57, v57
    v_smfmac_f32_32x32x32_bf16 v[40:55], v[100:103], v[80:87], v3
    v_exp_f32 v58, v58
    v_exp_f32 v59, v59
    v_exp_f32 v60, v60
    v_mfma_f32_32x32x16_bf16 v[72:87], v[88:91], v[16:19], v[24:39]
    v_exp_f32 v61, v61
    v_exp_f32 v62, v62
    v_exp_f32 v63, v63
    v_exp_f32 v64, v64
    v_exp_f32 v65, v65
    v_smfmac_f32_32x32x32_bf16 v[40:55], v[96:99], v[56:63], v3
    v_exp_f32 v66, v66
    v_exp_f32 v67, v67
    v_exp_f32 v68, v68
    v_exp_f32 v69, v69
    v_exp_f32 v70, v70
    v_exp_f32 v71, v71
    v_exp_f32 v72, v72
    v_exp_f32 v73, v73
    v_smfmac_f32_32x32x32_bf16 v[40:55], v[108:111], v[64:71], v3
    v_exp_f32 v74, v74
    v_exp_f32 v75, v75
    v_exp_f32 v76, v76
    v_mfma_f32_32x32x16_bf16 v[56:71], v[92:95], v[16:19], v[24:39]
    v_exp_f32 v77, v77
    v_exp_f32 v78, v78
    v_exp_f32 v79, v79
    v_exp_f32 v80, v80
    v_exp_f32 v81, v81
    v_smfmac_f32_32x32x32_bf16 v[40:55], v[104:107], v[72:79], v3
    v_exp_f32 v82, v82
    v_exp_f32 v83, v83
    v_exp_f32 v84, v84
    v_exp_f32 v85, v85
    v_exp_f32 v86, v86
    s_setprio 2
    v_exp_f32 v87, v87
    s_setprio 0
    s_mov_b64 exec, s[80:81]
    ds_read_b128 v[100:103], v1 offset:48384
    ds_read_b128 v[96:99], v1 offset:50176
    ds_read_b128 v[108:111], v1 offset:50432
    ds_read_b128 v[104:107], v1 offset:52224
    s_mov_b64 exec, -1
    ds_read_b128 v[88:91], v1 offset:51200
    ds_read_b128 v[92:95], v1 offset:53248
    s_waitcnt lgkmcnt(0)
    v_exp_f32 v56, v56
    s_setprio 1
    v_exp_f32 v57, v57
    v_smfmac_f32_32x32x32_bf16 v[40:55], v[100:103], v[80:87], v3
    v_exp_f32 v58, v58
    v_exp_f32 v59, v59
    v_exp_f32 v60, v60
    v_mfma_f32_32x32x16_bf16 v[72:87], v[88:91], v[16:19], v[24:39]
    v_exp_f32 v61, v61
    v_exp_f32 v62, v62
    v_exp_f32 v63, v63
    v_exp_f32 v64, v64
    v_exp_f32 v65, v65
    v_smfmac_f32_32x32x32_bf16 v[40:55], v[96:99], v[56:63], v3
    v_exp_f32 v66, v66
    v_exp_f32 v67, v67
    v_exp_f32 v68, v68
    v_exp_f32 v69, v69
    v_exp_f32 v70, v70
    v_exp_f32 v71, v71
    v_exp_f32 v72, v72
    v_exp_f32 v73, v73
    v_smfmac_f32_32x32x32_bf16 v[40:55], v[108:111], v[64:71], v3
    v_exp_f32 v74, v74
    v_exp_f32 v75, v75
    v_exp_f32 v76, v76
    v_mfma_f32_32x32x16_bf16 v[56:71], v[92:95], v[16:19], v[24:39]
    v_exp_f32 v77, v77
    v_exp_f32 v78, v78
    v_exp_f32 v79, v79
    v_exp_f32 v80, v80
    v_exp_f32 v81, v81
    v_smfmac_f32_32x32x32_bf16 v[40:55], v[104:107], v[72:79], v3
    v_exp_f32 v82, v82
    v_exp_f32 v83, v83
    v_exp_f32 v84, v84
    v_exp_f32 v85, v85
    v_exp_f32 v86, v86
    s_setprio 2
    v_exp_f32 v87, v87
    s_setprio 0
    s_mov_b64 exec, s[80:81]
    ds_read_b128 v[100:103], v1 offset:52480
    ds_read_b128 v[96:99], v1 offset:54272
    ds_read_b128 v[108:111], v1 offset:54528
    ds_read_b128 v[104:107], v1 offset:56320
    s_mov_b64 exec, -1
    ds_read_b128 v[88:91], v1 offset:55296
    ds_read_b128 v[92:95], v1 offset:57344
    s_waitcnt lgkmcnt(0)
    v_exp_f32 v56, v56
    s_setprio 1
    v_exp_f32 v57, v57
    v_smfmac_f32_32x32x32_bf16 v[40:55], v[100:103], v[80:87], v3
    v_exp_f32 v58, v58
    v_exp_f32 v59, v59
    v_exp_f32 v60, v60
    v_mfma_f32_32x32x16_bf16 v[72:87], v[88:91], v[16:19], v[24:39]
    v_exp_f32 v61, v61
    v_exp_f32 v62, v62
    v_exp_f32 v63, v63
    v_exp_f32 v64, v64
    v_exp_f32 v65, v65
    v_smfmac_f32_32x32x32_bf16 v[40:55], v[96:99], v[56:63], v3
    v_exp_f32 v66, v66
    v_exp_f32 v67, v67
    v_exp_f32 v68, v68
    v_exp_f32 v69, v69
    v_exp_f32 v70, v70
    v_exp_f32 v71, v71
    v_exp_f32 v72, v72
    v_exp_f32 v73, v73
    v_smfmac_f32_32x32x32_bf16 v[40:55], v[108:111], v[64:71], v3
    v_exp_f32 v74, v74
    v_exp_f32 v75, v75
    v_exp_f32 v76, v76
    v_mfma_f32_32x32x16_bf16 v[56:71], v[92:95], v[16:19], v[24:39]
    v_exp_f32 v77, v77
    v_exp_f32 v78, v78
    v_exp_f32 v79, v79
    v_exp_f32 v80, v80
    v_exp_f32 v81, v81
    v_smfmac_f32_32x32x32_bf16 v[40:55], v[104:107], v[72:79], v3
    v_exp_f32 v82, v82
    v_exp_f32 v83, v83
    v_exp_f32 v84, v84
    v_exp_f32 v85, v85
    v_exp_f32 v86, v86
    s_setprio 2
    v_exp_f32 v87, v87
    s_setprio 0
    s_mov_b64 exec, s[80:81]
    ds_read_b128 v[100:103], v1 offset:56576
    ds_read_b128 v[96:99], v1 offset:58368
    ds_read_b128 v[108:111], v1 offset:58624
    ds_read_b128 v[104:107], v1 offset:60416
    s_mov_b64 exec, -1
    ds_read_b128 v[88:91], v1 offset:59392
    ds_read_b128 v[92:95], v1 offset:61440
    ds_read_b32 v164, v163 offset:24
    s_waitcnt lgkmcnt(0)
    s_mov_b64 exec, 1
    ds_add_u32 v163, v13 offset:4
    s_mov_b64 exec, -1
    v_exp_f32 v56, v56
    s_setprio 1
    v_exp_f32 v57, v57
    v_smfmac_f32_32x32x32_bf16 v[40:55], v[100:103], v[80:87], v3
    v_exp_f32 v58, v58
    v_exp_f32 v59, v59
    v_exp_f32 v60, v60
    v_mfma_f32_32x32x16_bf16 v[72:87], v[88:91], v[16:19], v[24:39]
    v_exp_f32 v61, v61
    v_exp_f32 v62, v62
    v_exp_f32 v63, v63
    v_exp_f32 v64, v64
    v_exp_f32 v65, v65
    v_smfmac_f32_32x32x32_bf16 v[40:55], v[96:99], v[56:63], v3
    v_exp_f32 v66, v66
    v_exp_f32 v67, v67
    v_exp_f32 v68, v68
    v_exp_f32 v69, v69
    v_exp_f32 v70, v70
    v_exp_f32 v71, v71
    v_exp_f32 v72, v72
    v_exp_f32 v73, v73
    v_smfmac_f32_32x32x32_bf16 v[40:55], v[108:111], v[64:71], v3
    v_exp_f32 v74, v74
    v_exp_f32 v75, v75
    v_exp_f32 v76, v76
    v_mfma_f32_32x32x16_bf16 v[56:71], v[92:95], v[16:19], v[24:39]
    v_exp_f32 v77, v77
    v_exp_f32 v78, v78
    v_exp_f32 v79, v79
    v_exp_f32 v80, v80
    v_exp_f32 v81, v81
    v_smfmac_f32_32x32x32_bf16 v[40:55], v[104:107], v[72:79], v3
    v_exp_f32 v82, v82
    v_exp_f32 v83, v83
    v_exp_f32 v84, v84
    v_exp_f32 v85, v85
    v_exp_f32 v86, v86
    v_readfirstlane_b32 s73, v164
    s_setprio 2
    v_exp_f32_e64 v87, v87
    s_setprio 0
    s_cmp_lt_u32 s73, 4
    s_cbranch_scc1 L_spin_kv2
L_ok_kv2:
    s_mov_b64 exec, s[80:81]
    ds_read_b128 v[100:103], v1 offset:60672
    ds_read_b128 v[96:99], v1 offset:62464
    ds_read_b128 v[108:111], v1 offset:62720
    ds_read_b128 v[104:107], v1 offset:64512
    s_mov_b64 exec, -1
    ds_read_b128 v[88:91], v1 offset:63488
    ds_read_b128 v[92:95], v2 offset:0
    s_waitcnt lgkmcnt(0)
    v_exp_f32 v56, v56
    s_setprio 1
    v_exp_f32 v57, v57
    v_smfmac_f32_32x32x32_bf16 v[40:55], v[100:103], v[80:87], v3
    v_exp_f32 v58, v58
    v_exp_f32 v59, v59
    v_exp_f32 v60, v60
    v_mfma_f32_32x32x16_bf16 v[72:87], v[88:91], v[16:19], v[24:39]
    v_exp_f32 v61, v61
    v_exp_f32 v62, v62
    v_exp_f32 v63, v63
    v_exp_f32 v64, v64
    v_exp_f32 v65, v65
    v_smfmac_f32_32x32x32_bf16 v[40:55], v[96:99], v[56:63], v3
    v_exp_f32 v66, v66
    v_exp_f32 v67, v67
    v_exp_f32 v68, v68
    v_exp_f32 v69, v69
    v_exp_f32 v70, v70
    v_exp_f32 v71, v71
    v_exp_f32 v72, v72
    v_exp_f32 v73, v73
    v_smfmac_f32_32x32x32_bf16 v[40:55], v[108:111], v[64:71], v3
    v_exp_f32 v74, v74
    v_exp_f32 v75, v75
    v_exp_f32 v76, v76
    v_mfma_f32_32x32x16_bf16 v[56:71], v[92:95], v[16:19], v[24:39]
    v_exp_f32 v77, v77
    v_exp_f32 v78, v78
    v_exp_f32 v79, v79
    v_exp_f32 v80, v80
    v_exp_f32 v81, v81
    v_smfmac_f32_32x32x32_bf16 v[40:55], v[104:107], v[72:79], v3
    v_exp_f32 v82, v82
    v_exp_f32 v83, v83
    v_exp_f32 v84, v84
    v_exp_f32 v85, v85
    v_exp_f32 v86, v86
    s_setprio 2
    v_exp_f32 v87, v87
    s_setprio 0
    s_mov_b64 exec, s[80:81]
    ds_read_b128 v[100:103], v1 offset:64768
    ds_read_b128 v[96:99], v2 offset:1024
    ds_read_b128 v[108:111], v2 offset:1280
    ds_read_b128 v[104:107], v2 offset:3072
    s_mov_b64 exec, -1
    ds_read_b128 v[88:91], v2 offset:2048
    ds_read_b128 v[92:95], v2 offset:4096
    s_waitcnt lgkmcnt(0)
    v_exp_f32 v56, v56
    s_setprio 1
    v_exp_f32 v57, v57
    v_smfmac_f32_32x32x32_bf16 v[40:55], v[100:103], v[80:87], v3
    v_exp_f32 v58, v58
    v_exp_f32 v59, v59
    v_exp_f32 v60, v60
    v_mfma_f32_32x32x16_bf16 v[72:87], v[88:91], v[16:19], v[24:39]
    v_exp_f32 v61, v61
    v_exp_f32 v62, v62
    v_exp_f32 v63, v63
    v_exp_f32 v64, v64
    v_exp_f32 v65, v65
    v_smfmac_f32_32x32x32_bf16 v[40:55], v[96:99], v[56:63], v3
    v_exp_f32 v66, v66
    v_exp_f32 v67, v67
    v_exp_f32 v68, v68
    v_exp_f32 v69, v69
    v_exp_f32 v70, v70
    v_exp_f32 v71, v71
    v_exp_f32 v72, v72
    v_exp_f32 v73, v73
    v_smfmac_f32_32x32x32_bf16 v[40:55], v[108:111], v[64:71], v3
    v_exp_f32 v74, v74
    v_exp_f32 v75, v75
    v_exp_f32 v76, v76
    v_mfma_f32_32x32x16_bf16 v[56:71], v[92:95], v[16:19], v[24:39]
    v_exp_f32 v77, v77
    v_exp_f32 v78, v78
    v_exp_f32 v79, v79
    v_exp_f32 v80, v80
    v_exp_f32 v81, v81
    v_smfmac_f32_32x32x32_bf16 v[40:55], v[104:107], v[72:79], v3
    v_exp_f32 v82, v82
    v_exp_f32 v83, v83
    v_exp_f32 v84, v84
    v_exp_f32 v85, v85
    v_exp_f32 v86, v86
    s_setprio 2
    v_exp_f32 v87, v87
    s_setprio 0
    s_mov_b64 exec, s[80:81]
    ds_read_b128 v[100:103], v2 offset:3328
    ds_read_b128 v[96:99], v2 offset:5120
    ds_read_b128 v[108:111], v2 offset:5376
    ds_read_b128 v[104:107], v2 offset:7168
    s_mov_b64 exec, -1
    ds_read_b128 v[88:91], v2 offset:6144
    ds_read_b128 v[92:95], v2 offset:8192
    s_waitcnt lgkmcnt(0)
    v_exp_f32 v56, v56
    s_setprio 1
    v_exp_f32 v57, v57
    v_smfmac_f32_32x32x32_bf16 v[40:55], v[100:103], v[80:87], v3
    v_exp_f32 v58, v58
    v_exp_f32 v59, v59
    v_exp_f32 v60, v60
    v_mfma_f32_32x32x16_bf16 v[72:87], v[88:91], v[16:19], v[24:39]
    v_exp_f32 v61, v61
    v_exp_f32 v62, v62
    v_exp_f32 v63, v63
    v_exp_f32 v64, v64
    v_exp_f32 v65, v65
    v_smfmac_f32_32x32x32_bf16 v[40:55], v[96:99], v[56:63], v3
    v_exp_f32 v66, v66
    v_exp_f32 v67, v67
    v_exp_f32 v68, v68
    v_exp_f32 v69, v69
    v_exp_f32 v70, v70
    v_exp_f32 v71, v71
    v_exp_f32 v72, v72
    v_exp_f32 v73, v73
    v_smfmac_f32_32x32x32_bf16 v[40:55], v[108:111], v[64:71], v3
    v_exp_f32 v74, v74
    v_exp_f32 v75, v75
    v_exp_f32 v76, v76
    v_mfma_f32_32x32x16_bf16 v[56:71], v[92:95], v[16:19], v[24:39]
    v_exp_f32 v77, v77
    v_exp_f32 v78, v78
    v_exp_f32 v79, v79
    v_exp_f32 v80, v80
    v_exp_f32 v81, v81
    v_smfmac_f32_32x32x32_bf16 v[40:55], v[104:107], v[72:79], v3
    v_exp_f32 v82, v82
    v_exp_f32 v83, v83
    v_exp_f32 v84, v84
    v_exp_f32 v85, v85
    v_exp_f32 v86, v86
    s_setprio 2
    v_exp_f32 v87, v87
    s_setprio 0
    s_mov_b64 exec, s[80:81]
    ds_read_b128 v[100:103], v2 offset:7424
    ds_read_b128 v[96:99], v2 offset:9216
    ds_read_b128 v[108:111], v2 offset:9472
    ds_read_b128 v[104:107], v2 offset:11264
    s_mov_b64 exec, -1
    ds_read_b128 v[88:91], v2 offset:10240
    ds_read_b128 v[92:95], v2 offset:12288
    s_waitcnt lgkmcnt(0)
    v_exp_f32 v56, v56
    s_setprio 1
    v_exp_f32 v57, v57
    v_smfmac_f32_32x32x32_bf16 v[40:55], v[100:103], v[80:87], v3
    v_exp_f32 v58, v58
    v_exp_f32 v59, v59
    v_exp_f32 v60, v60
    v_mfma_f32_32x32x16_bf16 v[72:87], v[88:91], v[16:19], v[24:39]
    v_exp_f32 v61, v61
    v_exp_f32 v62, v62
    v_exp_f32 v63, v63
    v_exp_f32 v64, v64
    v_exp_f32 v65, v65
    v_smfmac_f32_32x32x32_bf16 v[40:55], v[96:99], v[56:63], v3
    v_exp_f32 v66, v66
    v_exp_f32 v67, v67
    v_exp_f32 v68, v68
    v_exp_f32 v69, v69
    v_exp_f32 v70, v70
    v_exp_f32 v71, v71
    v_exp_f32 v72, v72
    v_exp_f32 v73, v73
    v_smfmac_f32_32x32x32_bf16 v[40:55], v[108:111], v[64:71], v3
    v_exp_f32 v74, v74
    v_exp_f32 v75, v75
    v_exp_f32 v76, v76
    v_mfma_f32_32x32x16_bf16 v[56:71], v[92:95], v[16:19], v[24:39]
    v_exp_f32 v77, v77
    v_exp_f32 v78, v78
    v_exp_f32 v79, v79
    v_exp_f32 v80, v80
    v_exp_f32 v81, v81
    v_smfmac_f32_32x32x32_bf16 v[40:55], v[104:107], v[72:79], v3
    v_exp_f32 v82, v82
    v_exp_f32 v83, v83
    v_exp_f32 v84, v84
    v_exp_f32 v85, v85
    v_exp_f32 v86, v86
    s_setprio 2
    v_exp_f32 v87, v87
    s_setprio 0
    s_mov_b64 exec, s[80:81]
    ds_read_b128 v[100:103], v2 offset:11520
    ds_read_b128 v[96:99], v2 offset:13312
    ds_read_b128 v[108:111], v2 offset:13568
    ds_read_b128 v[104:107], v2 offset:15360
    s_mov_b64 exec, -1
    ds_read_b128 v[88:91], v2 offset:14336
    ds_read_b128 v[92:95], v2 offset:16384
    s_waitcnt lgkmcnt(0)
    v_exp_f32 v56, v56
    s_setprio 1
    v_exp_f32 v57, v57
    v_smfmac_f32_32x32x32_bf16 v[40:55], v[100:103], v[80:87], v3
    v_exp_f32 v58, v58
    v_exp_f32 v59, v59
    v_exp_f32 v60, v60
    v_mfma_f32_32x32x16_bf16 v[72:87], v[88:91], v[16:19], v[24:39]
    v_exp_f32 v61, v61
    v_exp_f32 v62, v62
    v_exp_f32 v63, v63
    v_exp_f32 v64, v64
    v_exp_f32 v65, v65
    v_smfmac_f32_32x32x32_bf16 v[40:55], v[96:99], v[56:63], v3
    v_exp_f32 v66, v66
    v_exp_f32 v67, v67
    v_exp_f32 v68, v68
    v_exp_f32 v69, v69
    v_exp_f32 v70, v70
    v_exp_f32 v71, v71
    v_exp_f32 v72, v72
    v_exp_f32 v73, v73
    v_smfmac_f32_32x32x32_bf16 v[40:55], v[108:111], v[64:71], v3
    v_exp_f32 v74, v74
    v_exp_f32 v75, v75
    v_exp_f32 v76, v76
    v_mfma_f32_32x32x16_bf16 v[56:71], v[92:95], v[16:19], v[24:39]
    v_exp_f32 v77, v77
    v_exp_f32 v78, v78
    v_exp_f32 v79, v79
    v_exp_f32 v80, v80
    v_exp_f32 v81, v81
    v_smfmac_f32_32x32x32_bf16 v[40:55], v[104:107], v[72:79], v3
    v_exp_f32 v82, v82
    v_exp_f32 v83, v83
    v_exp_f32 v84, v84
    v_exp_f32 v85, v85
    v_exp_f32 v86, v86
    s_setprio 2
    v_exp_f32 v87, v87
    s_setprio 0
    s_mov_b64 exec, s[80:81]
    ds_read_b128 v[100:103], v2 offset:15616
    ds_read_b128 v[96:99], v2 offset:17408
    ds_read_b128 v[108:111], v2 offset:17664
    ds_read_b128 v[104:107], v2 offset:19456
    s_mov_b64 exec, -1
    ds_read_b128 v[88:91], v2 offset:18432
    ds_read_b128 v[92:95], v2 offset:20480
    ds_read_b32 v164, v163 offset:0
    s_waitcnt lgkmcnt(0)
    v_exp_f32 v56, v56
    s_setprio 1
    v_exp_f32 v57, v57
    v_smfmac_f32_32x32x32_bf16 v[40:55], v[100:103], v[80:87], v3
    v_exp_f32 v58, v58
    v_exp_f32 v59, v59
    v_exp_f32 v60, v60
    v_mfma_f32_32x32x16_bf16 v[72:87], v[88:91], v[16:19], v[24:39]
    v_exp_f32 v61, v61
    v_exp_f32 v62, v62
    v_exp_f32 v63, v63
    v_exp_f32 v64, v64
    v_exp_f32 v65, v65
    v_smfmac_f32_32x32x32_bf16 v[40:55], v[96:99], v[56:63], v3
    v_exp_f32 v66, v66
    v_exp_f32 v67, v67
    v_exp_f32 v68, v68
    v_exp_f32 v69, v69
    v_exp_f32 v70, v70
    v_exp_f32 v71, v71
    v_exp_f32 v72, v72
    v_exp_f32 v73, v73
    v_smfmac_f32_32x32x32_bf16 v[40:55], v[108:111], v[64:71], v3
    v_exp_f32 v74, v74
    v_exp_f32 v75, v75
    v_exp_f32 v76, v76
    v_mfma_f32_32x32x16_bf16 v[56:71], v[92:95], v[16:19], v[24:39]
    v_exp_f32 v77, v77
    v_exp_f32 v78, v78
    v_exp_f32 v79, v79
    v_exp_f32 v80, v80
    v_exp_f32 v81, v81
    v_smfmac_f32_32x32x32_bf16 v[40:55], v[104:107], v[72:79], v3
    v_exp_f32 v82, v82
    v_exp_f32 v83, v83
    v_exp_f32 v84, v84
    v_exp_f32 v85, v85
    v_exp_f32 v86, v86
    v_readfirstlane_b32 s73, v164
    s_setprio 2
    v_exp_f32 v87, v87
    s_setprio 0
    s_cmp_lt_u32 s73, 288
    s_cbranch_scc1 L_spin_s2
L_ok_s2:
    buffer_load_dwordx4 v[112:115], v166, s[44:47], 0 offen sc1
    s_mov_b64 exec, s[80:81]
    ds_read_b128 v[100:103], v2 offset:19712
    ds_read_b128 v[96:99], v2 offset:21504
    ds_read_b128 v[108:111], v2 offset:21760
    ds_read_b128 v[104:107], v2 offset:23552
    s_mov_b64 exec, -1
    ds_read_b128 v[88:91], v2 offset:22528
    ds_read_b128 v[92:95], v2 offset:24576
    s_waitcnt lgkmcnt(0)
    v_exp_f32 v56, v56
    s_setprio 1
    v_exp_f32 v57, v57
    v_smfmac_f32_32x32x32_bf16 v[40:55], v[100:103], v[80:87], v3
    v_exp_f32 v58, v58
    v_exp_f32 v59, v59
    v_exp_f32 v60, v60
    v_mfma_f32_32x32x16_bf16 v[72:87], v[88:91], v[16:19], v[24:39]
    v_exp_f32 v61, v61
    v_exp_f32 v62, v62
    v_exp_f32 v63, v63
    v_exp_f32 v64, v64
    v_exp_f32 v65, v65
    v_smfmac_f32_32x32x32_bf16 v[40:55], v[96:99], v[56:63], v3
    v_exp_f32 v66, v66
    v_exp_f32 v67, v67
    v_exp_f32 v68, v68
    v_exp_f32 v69, v69
    v_exp_f32 v70, v70
    v_exp_f32 v71, v71
    v_exp_f32 v72, v72
    v_exp_f32 v73, v73
    v_smfmac_f32_32x32x32_bf16 v[40:55], v[108:111], v[64:71], v3
    v_exp_f32 v74, v74
    v_exp_f32 v75, v75
    v_exp_f32 v76, v76
    v_mfma_f32_32x32x16_bf16 v[56:71], v[92:95], v[16:19], v[24:39]
    v_exp_f32 v77, v77
    v_exp_f32 v78, v78
    v_exp_f32 v79, v79
    v_exp_f32 v80, v80
    v_exp_f32 v81, v81
    v_smfmac_f32_32x32x32_bf16 v[40:55], v[104:107], v[72:79], v3
    v_exp_f32 v82, v82
    v_exp_f32 v83, v83
    v_exp_f32 v84, v84
    v_exp_f32 v85, v85
    v_exp_f32 v86, v86
    s_setprio 3
    v_exp_f32 v87, v87
    s_setprio 0
    s_mov_b64 exec, s[80:81]
    ds_read_b128 v[100:103], v2 offset:23808
    ds_read_b128 v[96:99], v2 offset:25600
    ds_read_b128 v[108:111], v2 offset:25856
    ds_read_b128 v[104:107], v2 offset:27648
    s_mov_b64 exec, -1
    ds_read_b128 v[88:91], v2 offset:26624
    ds_read_b128 v[92:95], v2 offset:28672
    s_waitcnt lgkmcnt(0) vmcnt(0)
    s_mov_b64 exec, 1
    ds_add_u32 v163, v13 offset:8
    s_mov_b64 exec, -1
    v_exp_f32 v56, v56
    s_setprio 2
    v_exp_f32 v57, v57
    v_smfmac_f32_32x32x32_bf16 v[40:55], v[100:103], v[80:87], v3
    v_exp_f32 v58, v58
    v_exp_f32 v59, v59
    v_exp_f32 v60, v60
    v_mfma_f32_32x32x16_bf16 v[72:87], v[88:91], v[16:19], v[24:39]
    v_exp_f32 v61, v61
    v_exp_f32 v62, v62
    v_exp_f32 v63, v63
    v_exp_f32 v64, v64
    v_exp_f32 v65, v65
    v_smfmac_f32_32x32x32_bf16 v[40:55], v[96:99], v[56:63], v3
    v_exp_f32 v66, v66
    v_exp_f32 v67, v67
    v_exp_f32 v68, v68
    v_mfma_f32_32x32x16_bf16 v[116:131], v[112:115], v[20:23], 0
    v_exp_f32 v69, v69
    v_exp_f32 v70, v70
    v_exp_f32 v71, v71
    v_exp_f32 v72, v72
    v_exp_f32 v73, v73
    v_smfmac_f32_32x32x32_bf16 v[40:55], v[108:111], v[64:71], v3
    v_exp_f32 v74, v74
    v_exp_f32 v75, v75
    v_exp_f32 v76, v76
    v_mfma_f32_32x32x16_bf16 v[56:71], v[92:95], v[16:19], v[24:39]
    v_exp_f32 v77, v77
    v_exp_f32 v78, v78
    v_exp_f32 v79, v79
    v_exp_f32 v80, v80
    v_exp_f32 v81, v81
    v_smfmac_f32_32x32x32_bf16 v[40:55], v[104:107], v[72:79], v3
    v_exp_f32 v82, v82
    v_exp_f32 v83, v83
    v_exp_f32 v84, v84
    v_exp_f32 v85, v85
    v_add_f32 v10, 0x358637bd, v124
    v_rcp_f32 v10, v10
    v_sub_f32 v9, 1.0, v4
    v_mul_f32 v10, v10, v9
    v_pk_mul_f32 v[116:117], v[116:117], v[10:11] op_sel_hi:[1,0]
    v_pk_mul_f32 v[118:119], v[118:119], v[10:11] op_sel_hi:[1,0]
    v_pk_mul_f32 v[120:121], v[120:121], v[10:11] op_sel_hi:[1,0]
    v_pk_mul_f32 v[122:123], v[122:123], v[10:11] op_sel_hi:[1,0]
    v_cvt_pk_bf16_f32 v124, v116, v117
    v_cvt_pk_bf16_f32 v125, v118, v119
    v_cvt_pk_bf16_f32 v126, v120, v121
    v_cvt_pk_bf16_f32 v127, v122, v123
    v_exp_f32 v86, v86
    s_setprio 3
    v_exp_f32_e64 v87, v87
    s_setprio 0
    s_mov_b64 exec, s[80:81]
    ds_read_b128 v[100:103], v2 offset:27904
    ds_read_b128 v[96:99], v2 offset:29696
    ds_read_b128 v[108:111], v2 offset:29952
    ds_read_b128 v[104:107], v2 offset:31744
    s_mov_b64 exec, -1
    ds_read_b128 v[88:91], v2 offset:30720
    ds_read_b128 v[92:95], v2 offset:32768
    s_xor_b32 s71, s83, 4096
    s_add_u32 s71, s71, 4194304
    buffer_store_dwordx4 v[124:127], v7, s[44:47], s71 offen sc1
    s_waitcnt lgkmcnt(0)
    v_exp_f32 v56, v56
    s_setprio 1
    v_exp_f32 v57, v57
    v_smfmac_f32_32x32x32_bf16 v[40:55], v[100:103], v[80:87], v3
    v_exp_f32 v58, v58
    v_exp_f32 v59, v59
    v_exp_f32 v60, v60
    v_mfma_f32_32x32x16_bf16 v[72:87], v[88:91], v[16:19], v[24:39]
    v_exp_f32 v61, v61
    v_exp_f32 v62, v62
    v_exp_f32 v63, v63
    v_exp_f32 v64, v64
    v_exp_f32 v65, v65
    v_smfmac_f32_32x32x32_bf16 v[40:55], v[96:99], v[56:63], v3
    v_exp_f32 v66, v66
    v_exp_f32 v67, v67
    v_exp_f32 v68, v68
    v_exp_f32 v69, v69
    v_exp_f32 v70, v70
    v_exp_f32 v71, v71
    v_exp_f32 v72, v72
    v_exp_f32 v73, v73
    v_smfmac_f32_32x32x32_bf16 v[40:55], v[108:111], v[64:71], v3
    v_exp_f32 v74, v74
    v_exp_f32 v75, v75
    v_exp_f32 v76, v76
    v_mfma_f32_32x32x16_bf16 v[56:71], v[92:95], v[16:19], v[24:39]
    v_exp_f32 v77, v77
    v_exp_f32 v78, v78
    v_exp_f32 v79, v79
    v_exp_f32 v80, v80
    v_exp_f32 v81, v81
    v_smfmac_f32_32x32x32_bf16 v[40:55], v[104:107], v[72:79], v3
    v_exp_f32 v82, v82
    v_exp_f32 v83, v83
    v_exp_f32 v84, v84
    v_exp_f32 v85, v85
    v_exp_f32 v86, v86
    s_setprio 2
    v_exp_f32 v87, v87
    s_setprio 0
    s_mov_b64 exec, s[80:81]
    ds_read_b128 v[100:103], v2 offset:32000
    ds_read_b128 v[96:99], v2 offset:33792
    ds_read_b128 v[108:111], v2 offset:34048
    ds_read_b128 v[104:107], v2 offset:35840
    s_mov_b64 exec, -1
    ds_read_b128 v[88:91], v2 offset:34816
    ds_read_b128 v[92:95], v2 offset:36864
    s_waitcnt lgkmcnt(0)
    v_exp_f32 v56, v56
    s_setprio 1
    v_exp_f32 v57, v57
    v_smfmac_f32_32x32x32_bf16 v[40:55], v[100:103], v[80:87], v3
    v_exp_f32 v58, v58
    v_exp_f32 v59, v59
    v_exp_f32 v60, v60
    v_mfma_f32_32x32x16_bf16 v[72:87], v[88:91], v[16:19], v[24:39]
    v_exp_f32 v61, v61
    v_exp_f32 v62, v62
    v_exp_f32 v63, v63
    v_exp_f32 v64, v64
    v_exp_f32 v65, v65
    v_smfmac_f32_32x32x32_bf16 v[40:55], v[96:99], v[56:63], v3
    v_exp_f32 v66, v66
    v_exp_f32 v67, v67
    v_exp_f32 v68, v68
    v_exp_f32 v69, v69
    v_exp_f32 v70, v70
    v_exp_f32 v71, v71
    v_exp_f32 v72, v72
    v_exp_f32 v73, v73
    v_smfmac_f32_32x32x32_bf16 v[40:55], v[108:111], v[64:71], v3
    v_exp_f32 v74, v74
    v_exp_f32 v75, v75
    v_exp_f32 v76, v76
    v_mfma_f32_32x32x16_bf16 v[56:71], v[92:95], v[16:19], v[24:39]
    v_exp_f32 v77, v77
    v_exp_f32 v78, v78
    v_exp_f32 v79, v79
    v_exp_f32 v80, v80
    v_exp_f32 v81, v81
    v_smfmac_f32_32x32x32_bf16 v[40:55], v[104:107], v[72:79], v3
    v_exp_f32 v82, v82
    v_exp_f32 v83, v83
    v_exp_f32 v84, v84
    v_exp_f32 v85, v85
    v_exp_f32 v86, v86
    s_setprio 2
    v_exp_f32 v87, v87
    s_setprio 0
    s_mov_b64 exec, s[80:81]
    ds_read_b128 v[100:103], v2 offset:36096
    ds_read_b128 v[96:99], v2 offset:37888
    ds_read_b128 v[108:111], v2 offset:38144
    ds_read_b128 v[104:107], v2 offset:39936
    s_mov_b64 exec, -1
    ds_read_b128 v[88:91], v2 offset:38912
    ds_read_b128 v[92:95], v2 offset:40960
    s_waitcnt lgkmcnt(0)
    v_exp_f32 v56, v56
    s_setprio 1
    v_exp_f32 v57, v57
    v_smfmac_f32_32x32x32_bf16 v[40:55], v[100:103], v[80:87], v3
    v_exp_f32 v58, v58
    v_exp_f32 v59, v59
    v_exp_f32 v60, v60
    v_mfma_f32_32x32x16_bf16 v[72:87], v[88:91], v[16:19], v[24:39]
    v_exp_f32 v61, v61
    v_exp_f32 v62, v62
    v_exp_f32 v63, v63
    v_exp_f32 v64, v64
    v_exp_f32 v65, v65
    v_smfmac_f32_32x32x32_bf16 v[40:55], v[96:99], v[56:63], v3
    v_exp_f32 v66, v66
    v_exp_f32 v67, v67
    v_exp_f32 v68, v68
    v_exp_f32 v69, v69
    v_exp_f32 v70, v70
    v_exp_f32 v71, v71
    v_exp_f32 v72, v72
    v_exp_f32 v73, v73
    v_smfmac_f32_32x32x32_bf16 v[40:55], v[108:111], v[64:71], v3
    v_exp_f32 v74, v74
    v_exp_f32 v75, v75
    v_exp_f32 v76, v76
    v_mfma_f32_32x32x16_bf16 v[56:71], v[92:95], v[16:19], v[24:39]
    v_exp_f32 v77, v77
    v_exp_f32 v78, v78
    v_exp_f32 v79, v79
    v_exp_f32 v80, v80
    v_exp_f32 v81, v81
    v_smfmac_f32_32x32x32_bf16 v[40:55], v[104:107], v[72:79], v3
    v_exp_f32 v82, v82
    v_exp_f32 v83, v83
    v_exp_f32 v84, v84
    v_exp_f32 v85, v85
    v_exp_f32 v86, v86
    s_setprio 2
    v_exp_f32 v87, v87
    s_setprio 0
    s_mov_b64 exec, s[80:81]
    ds_read_b128 v[100:103], v2 offset:40192
    ds_read_b128 v[96:99], v2 offset:41984
    ds_read_b128 v[108:111], v2 offset:42240
    ds_read_b128 v[104:107], v2 offset:44032
    s_mov_b64 exec, -1
    ds_read_b128 v[88:91], v2 offset:43008
    ds_read_b128 v[92:95], v2 offset:45056
    ds_read_b32 v164, v163 offset:16
    s_waitcnt lgkmcnt(0)
    s_mov_b64 exec, 1
    ds_add_u32 v163, v13 offset:12
    s_mov_b64 exec, -1
    v_exp_f32 v56, v56
    s_setprio 1
    v_exp_f32 v57, v57
    v_smfmac_f32_32x32x32_bf16 v[40:55], v[100:103], v[80:87], v3
    v_exp_f32 v58, v58
    v_exp_f32 v59, v59
    v_exp_f32 v60, v60
    v_mfma_f32_32x32x16_bf16 v[72:87], v[88:91], v[16:19], v[24:39]
    v_exp_f32 v61, v61
    v_exp_f32 v62, v62
    v_exp_f32 v63, v63
    v_exp_f32 v64, v64
    v_exp_f32 v65, v65
    v_smfmac_f32_32x32x32_bf16 v[40:55], v[96:99], v[56:63], v3
    v_exp_f32 v66, v66
    v_exp_f32 v67, v67
    v_exp_f32 v68, v68
    v_exp_f32 v69, v69
    v_exp_f32 v70, v70
    v_exp_f32 v71, v71
    v_exp_f32 v72, v72
    v_exp_f32 v73, v73
    v_smfmac_f32_32x32x32_bf16 v[40:55], v[108:111], v[64:71], v3
    v_exp_f32 v74, v74
    v_exp_f32 v75, v75
    v_exp_f32 v76, v76
    v_mfma_f32_32x32x16_bf16 v[56:71], v[92:95], v[16:19], v[24:39]
    v_exp_f32 v77, v77
    v_exp_f32 v78, v78
    v_exp_f32 v79, v79
    v_exp_f32 v80, v80
    v_exp_f32 v81, v81
    v_smfmac_f32_32x32x32_bf16 v[40:55], v[104:107], v[72:79], v3
    v_exp_f32 v82, v82
    v_exp_f32 v83, v83
    v_exp_f32 v84, v84
    v_exp_f32 v85, v85
    v_exp_f32 v86, v86
    v_readfirstlane_b32 s73, v164
    s_setprio 2
    v_exp_f32_e64 v87, v87
    s_setprio 0
    s_cmp_lt_u32 s73, 4
    s_cbranch_scc1 L_spin_w
L_ok_w:
    s_mov_b64 exec, s[80:81]
    ds_read_b128 v[100:103], v2 offset:44288
    ds_read_b128 v[96:99], v2 offset:46080
    ds_read_b128 v[108:111], v2 offset:46336
    ds_read_b128 v[104:107], v2 offset:48128
    s_mov_b64 exec, -1
    ds_read_b128 v[88:91], v2 offset:47104
    ds_read_b128 v[92:95], v2 offset:49152
    s_waitcnt lgkmcnt(0)
    v_exp_f32 v56, v56
    s_setprio 1
    v_exp_f32 v57, v57
    v_smfmac_f32_32x32x32_bf16 v[40:55], v[100:103], v[80:87], v3
    v_exp_f32 v58, v58
    v_exp_f32 v59, v59
    v_exp_f32 v60, v60
    v_mfma_f32_32x32x16_bf16 v[72:87], v[88:91], v[16:19], v[24:39]
    v_exp_f32 v61, v61
    v_exp_f32 v62, v62
    v_exp_f32 v63, v63
    v_exp_f32 v64, v64
    v_exp_f32 v65, v65
    v_smfmac_f32_32x32x32_bf16 v[40:55], v[96:99], v[56:63], v3
    v_exp_f32 v66, v66
    v_exp_f32 v67, v67
    v_exp_f32 v68, v68
    v_exp_f32 v69, v69
    v_exp_f32 v70, v70
    v_exp_f32 v71, v71
    v_exp_f32 v72, v72
    v_exp_f32 v73, v73
    v_smfmac_f32_32x32x32_bf16 v[40:55], v[108:111], v[64:71], v3
    v_exp_f32 v74, v74
    v_exp_f32 v75, v75
    v_exp_f32 v76, v76
    v_mfma_f32_32x32x16_bf16 v[56:71], v[92:95], v[16:19], v[24:39]
    v_exp_f32 v77, v77
    v_exp_f32 v78, v78
    v_exp_f32 v79, v79
    v_exp_f32 v80, v80
    v_exp_f32 v81, v81
    v_smfmac_f32_32x32x32_bf16 v[40:55], v[104:107], v[72:79], v3
    v_exp_f32 v82, v82
    v_exp_f32 v83, v83
    v_exp_f32 v84, v84
    v_exp_f32 v85, v85
    v_exp_f32 v86, v86
    s_setprio 2
    v_exp_f32 v87, v87
    s_setprio 0
    s_mov_b64 exec, s[80:81]
    ds_read_b128 v[100:103], v2 offset:48384
    ds_read_b128 v[96:99], v2 offset:50176
    ds_read_b128 v[108:111], v2 offset:50432
    ds_read_b128 v[104:107], v2 offset:52224
    s_mov_b64 exec, -1
    ds_read_b128 v[88:91], v2 offset:51200
    ds_read_b128 v[92:95], v2 offset:53248
    s_waitcnt lgkmcnt(0)
    v_exp_f32 v56, v56
    s_setprio 1
    v_exp_f32 v57, v57
    v_smfmac_f32_32x32x32_bf16 v[40:55], v[100:103], v[80:87], v3
    v_exp_f32 v58, v58
    v_exp_f32 v59, v59
    v_exp_f32 v60, v60
    v_mfma_f32_32x32x16_bf16 v[72:87], v[88:91], v[16:19], v[24:39]
    v_exp_f32 v61, v61
    v_exp_f32 v62, v62
    v_exp_f32 v63, v63
    v_exp_f32 v64, v64
    v_exp_f32 v65, v65
    v_smfmac_f32_32x32x32_bf16 v[40:55], v[96:99], v[56:63], v3
    v_exp_f32 v66, v66
    v_exp_f32 v67, v67
    v_exp_f32 v68, v68
    v_exp_f32 v69, v69
    v_exp_f32 v70, v70
    v_exp_f32 v71, v71
    v_exp_f32 v72, v72
    v_exp_f32 v73, v73
    v_smfmac_f32_32x32x32_bf16 v[40:55], v[108:111], v[64:71], v3
    v_exp_f32 v74, v74
    v_exp_f32 v75, v75
    v_exp_f32 v76, v76
    v_mfma_f32_32x32x16_bf16 v[56:71], v[92:95], v[16:19], v[24:39]
    v_exp_f32 v77, v77
    v_exp_f32 v78, v78
    v_exp_f32 v79, v79
    v_exp_f32 v80, v80
    v_exp_f32 v81, v81
    v_smfmac_f32_32x32x32_bf16 v[40:55], v[104:107], v[72:79], v3
    v_exp_f32 v82, v82
    v_exp_f32 v83, v83
    v_exp_f32 v84, v84
    v_exp_f32 v85, v85
    v_exp_f32 v86, v86
    s_setprio 2
    v_exp_f32 v87, v87
    s_setprio 0
    s_mov_b64 exec, s[80:81]
    ds_read_b128 v[100:103], v2 offset:52480
    ds_read_b128 v[96:99], v2 offset:54272
    ds_read_b128 v[108:111], v2 offset:54528
    ds_read_b128 v[104:107], v2 offset:56320
    s_mov_b64 exec, -1
    ds_read_b128 v[88:91], v2 offset:55296
    ds_read_b128 v[92:95], v2 offset:57344
    s_add_u32 s71, s93, 4194304
    buffer_load_dwordx4 v[112:115], v5, s[44:47], s71 offen offset:0 sc1
    buffer_load_dwordx4 v[116:119], v5, s[44:47], s71 offen offset:2048 sc1
    s_add_u32 s71, s93, 4198400
    buffer_load_dwordx4 v[120:123], v5, s[44:47], s71 offen offset:0 sc1
    s_waitcnt lgkmcnt(0)
    v_exp_f32 v56, v56
    s_setprio 1
    v_exp_f32 v57, v57
    v_smfmac_f32_32x32x32_bf16 v[40:55], v[100:103], v[80:87], v3
    v_exp_f32 v58, v58
    v_exp_f32 v59, v59
    v_exp_f32 v60, v60
    v_mfma_f32_32x32x16_bf16 v[72:87], v[88:91], v[16:19], v[24:39]
    v_exp_f32 v61, v61
    v_exp_f32 v62, v62
    v_exp_f32 v63, v63
    v_exp_f32 v64, v64
    v_exp_f32 v65, v65
    v_smfmac_f32_32x32x32_bf16 v[40:55], v[96:99], v[56:63], v3
    v_exp_f32 v66, v66
    v_exp_f32 v67, v67
    v_exp_f32 v68, v68
    v_exp_f32 v69, v69
    v_exp_f32 v70, v70
    v_exp_f32 v71, v71
    v_exp_f32 v72, v72
    v_exp_f32 v73, v73
    v_smfmac_f32_32x32x32_bf16 v[40:55], v[108:111], v[64:71], v3
    v_exp_f32 v74, v74
    v_exp_f32 v75, v75
    v_exp_f32 v76, v76
    v_mfma_f32_32x32x16_bf16 v[56:71], v[92:95], v[16:19], v[24:39]
    v_exp_f32 v77, v77
    v_exp_f32 v78, v78
    v_exp_f32 v79, v79
    v_exp_f32 v80, v80
    v_exp_f32 v81, v81
    v_smfmac_f32_32x32x32_bf16 v[40:55], v[104:107], v[72:79], v3
    v_exp_f32 v82, v82
    v_exp_f32 v83, v83
    v_exp_f32 v84, v84
    v_exp_f32 v85, v85
    v_exp_f32 v86, v86
    s_setprio 2
    v_exp_f32 v87, v87
    s_setprio 0
    s_mov_b64 exec, s[80:81]
    ds_read_b128 v[100:103], v2 offset:56576
    ds_read_b128 v[96:99], v2 offset:58368
    ds_read_b128 v[108:111], v2 offset:58624
    ds_read_b128 v[104:107], v2 offset:60416
    s_mov_b64 exec, -1
    ds_read_b128 v[88:91], v2 offset:59392
    ds_read_b128 v[92:95], v2 offset:61440
    s_add_u32 s71, s93, 4198400
    buffer_load_dwordx4 v[124:127], v5, s[44:47], s71 offen offset:2048 sc1
    s_add_u32 s71, s93, 4210688
    buffer_load_dwordx4 v[128:131], v5, s[44:47], s71 offen offset:0 sc1
    buffer_load_dwordx4 v[132:135], v5, s[44:47], s71 offen offset:2048 sc1
    s_waitcnt lgkmcnt(0)
    v_exp_f32 v56, v56
    s_setprio 1
    v_exp_f32 v57, v57
    v_smfmac_f32_32x32x32_bf16 v[40:55], v[100:103], v[80:87], v3
    v_exp_f32 v58, v58
    v_exp_f32 v59, v59
    v_exp_f32 v60, v60
    v_mfma_f32_32x32x16_bf16 v[72:87], v[88:91], v[16:19], v[24:39]
    v_exp_f32 v61, v61
    v_exp_f32 v62, v62
    v_exp_f32 v63, v63
    v_exp_f32 v64, v64
    v_exp_f32 v65, v65
    v_smfmac_f32_32x32x32_bf16 v[40:55], v[96:99], v[56:63], v3
    v_exp_f32 v66, v66
    v_exp_f32 v67, v67
    v_exp_f32 v68, v68
    v_exp_f32 v69, v69
    v_exp_f32 v70, v70
    v_exp_f32 v71, v71
    v_exp_f32 v72, v72
    v_exp_f32 v73, v73
    v_smfmac_f32_32x32x32_bf16 v[40:55], v[108:111], v[64:71], v3
    v_exp_f32 v74, v74
    v_exp_f32 v75, v75
    v_exp_f32 v76, v76
    v_mfma_f32_32x32x16_bf16 v[56:71], v[92:95], v[16:19], v[24:39]
    v_exp_f32 v77, v77
    v_exp_f32 v78, v78
    v_exp_f32 v79, v79
    v_exp_f32 v80, v80
    v_exp_f32 v81, v81
    v_smfmac_f32_32x32x32_bf16 v[40:55], v[104:107], v[72:79], v3
    v_exp_f32 v82, v82
    v_exp_f32 v83, v83
    v_exp_f32 v84, v84
    v_exp_f32 v85, v85
    v_exp_f32 v86, v86
    s_setprio 2
    v_exp_f32 v87, v87
    s_setprio 0
    s_mov_b64 exec, s[80:81]
    ds_read_b128 v[100:103], v2 offset:60672
    ds_read_b128 v[96:99], v2 offset:62464
    ds_read_b128 v[108:111], v2 offset:62720
    ds_read_b128 v[104:107], v2 offset:64512
    s_mov_b64 exec, -1
    ds_read_b128 v[88:91], v2 offset:63488
    s_add_u32 s71, s93, 4214784
    buffer_load_dwordx4 v[136:139], v5, s[44:47], s71 offen offset:0 sc1
    buffer_load_dwordx4 v[140:143], v5, s[44:47], s71 offen offset:2048 sc1
    s_waitcnt lgkmcnt(0)
    v_exp_f32 v56, v56
    s_setprio 1
    v_exp_f32 v57, v57
    v_smfmac_f32_32x32x32_bf16 v[40:55], v[100:103], v[80:87], v3
    s_mov_b64 exec, s[80:81]
    ds_read_b128 v[100:103], v2 offset:64768
    s_mov_b64 exec, -1
    v_exp_f32 v58, v58
    v_exp_f32 v59, v59
    v_exp_f32 v60, v60
    v_mfma_f32_32x32x16_bf16 v[72:87], v[88:91], v[16:19], v[24:39]
    v_exp_f32 v61, v61
    v_exp_f32 v62, v62
    v_exp_f32 v63, v63
    v_exp_f32 v64, v64
    v_exp_f32 v65, v65
    v_smfmac_f32_32x32x32_bf16 v[40:55], v[96:99], v[56:63], v3
    v_exp_f32 v66, v66
    v_exp_f32 v67, v67
    v_exp_f32 v68, v68
    v_exp_f32 v69, v69
    v_exp_f32 v70, v70
    v_exp_f32 v71, v71
    v_exp_f32 v72, v72
    v_exp_f32 v73, v73
    v_smfmac_f32_32x32x32_bf16 v[40:55], v[108:111], v[64:71], v3
    v_exp_f32 v74, v74
    v_exp_f32 v75, v75
    v_exp_f32 v76, v76
    v_exp_f32 v77, v77
    v_exp_f32 v78, v78
    v_exp_f32 v79, v79
    v_exp_f32 v80, v80
    v_exp_f32 v81, v81
    v_smfmac_f32_32x32x32_bf16 v[40:55], v[104:107], v[72:79], v3
    v_exp_f32 v82, v82
    v_exp_f32 v83, v83
    v_exp_f32 v84, v84
    v_exp_f32 v85, v85
    v_exp_f32 v86, v86
    v_exp_f32 v87, v87
    s_setprio 2
    s_waitcnt lgkmcnt(0)
    v_smfmac_f32_32x32x32_bf16 v[40:55], v[100:103], v[80:87], v3
    v_lshrrev_b32 v9, 1, v1
    v_mul_f32 v8, 0x2f800000, v4
    s_mov_b32 s73, 0x0e000000
    s_mov_b32 s74, 0x5f800000
    v_add_u32 v160, 0x10000, v14
    v_add_u32 v161, 0x20000, v14
    s_add_u32 s71, s83, 2097152
    v_add_u32 v162, s69, v9
    v_add_u32 v165, s70, v9
    s_mov_b32 s82, 262144
    s_nop 1
    v_rcp_f32 v10, v48
    v_add_f32 v9, |v40|, |v41|
    v_add_f32 v11, |v42|, |v43|
    v_add_f32 v9, v9, |v44|
    v_add_f32 v11, v11, |v45|
    v_add_f32 v9, v9, |v46|
    v_add_f32 v11, v11, |v47|
    v_add_f32 v9, v9, v11
    v_cmp_ngt_f32 s[86:87], s74, v48
    v_med3_f32 v11, v9, s73, v12
    v_cmp_neq_f32 vcc, v9, v11
    v_mul_f32_e64 v10, v10, v8
    s_or_b64 vcc, vcc, s[86:87]
    s_cbranch_vccnz L_fallback
L_norm:
    v_pk_mul_f32 v[40:41], v[40:41], v[10:11] op_sel_hi:[1,0]
    v_pk_mul_f32 v[42:43], v[42:43], v[10:11] op_sel_hi:[1,0]
    v_pk_mul_f32 v[44:45], v[44:45], v[10:11] op_sel_hi:[1,0]
    v_pk_mul_f32 v[46:47], v[46:47], v[10:11] op_sel_hi:[1,0]
    v_cvt_pk_bf16_f32 v16, v40, v41
    v_cvt_pk_bf16_f32 v17, v42, v43
    v_cvt_pk_bf16_f32 v18, v44, v45
    v_cvt_pk_bf16_f32 v19, v46, v47
    buffer_store_dwordx4 v[16:19], v7, s[44:47], s71 offen sc1
    ds_read_b128 v[56:59], v14 offset:0
    ds_read_b128 v[60:63], v14 offset:1024
    ds_read_b128 v[64:67], v14 offset:2048
    ds_read_b128 v[68:71], v14 offset:3072
    ds_read_b128 v[72:75], v14 offset:8192
    ds_read_b128 v[76:79], v14 offset:9216
    ds_read_b128 v[80:83], v14 offset:10240
    ds_read_b128 v[84:87], v14 offset:11264
    s_waitcnt vmcnt(1)
    s_barrier
L_okB:
    s_setprio 3
    s_waitcnt lgkmcnt(4)
    v_mfma_f32_16x16x32_bf16 v[144:147], v[112:115], v[56:59], 0
    ds_read_b128 v[88:91], v14 offset:16384
    v_mfma_f32_16x16x32_bf16 v[148:151], v[112:115], v[60:63], 0
    ds_read_b128 v[92:95], v14 offset:17408
    v_mfma_f32_16x16x32_bf16 v[152:155], v[112:115], v[64:67], 0
    ds_read_b128 v[96:99], v14 offset:18432
    v_mfma_f32_16x16x32_bf16 v[156:159], v[112:115], v[68:71], 0
    ds_read_b128 v[100:103], v14 offset:19456
    s_waitcnt lgkmcnt(4)
    v_mfma_f32_16x16x32_bf16 v[144:147], v[116:119], v[72:75], v[144:147]
    ds_read_b128 v[56:59], v14 offset:24576
    v_mfma_f32_16x16x32_bf16 v[148:151], v[116:119], v[76:79], v[148:151]
    ds_read_b128 v[60:63], v14 offset:25600
    v_mfma_f32_16x16x32_bf16 v[152:155], v[116:119], v[80:83], v[152:155]
    ds_read_b128 v[64:67], v14 offset:26624
    v_mfma_f32_16x16x32_bf16 v[156:159], v[116:119], v[84:87], v[156:159]
    ds_read_b128 v[68:71], v14 offset:27648
    s_waitcnt lgkmcnt(4)
    v_mfma_f32_16x16x32_bf16 v[144:147], v[120:123], v[88:91], v[144:147]
    ds_read_b128 v[72:75], v14 offset:32768
    v_mfma_f32_16x16x32_bf16 v[148:151], v[120:123], v[92:95], v[148:151]
    ds_read_b128 v[76:79], v14 offset:33792
    v_mfma_f32_16x16x32_bf16 v[152:155], v[120:123], v[96:99], v[152:155]
    ds_read_b128 v[80:83], v14 offset:34816
    v_mfma_f32_16x16x32_bf16 v[156:159], v[120:123], v[100:103], v[156:159]
    ds_read_b128 v[84:87], v14 offset:35840
    s_waitcnt lgkmcnt(4)
    v_mfma_f32_16x16x32_bf16 v[144:147], v[124:127], v[56:59], v[144:147]
    ds_read_b128 v[88:91], v14 offset:40960
    v_mfma_f32_16x16x32_bf16 v[148:151], v[124:127], v[60:63], v[148:151]
    ds_read_b128 v[92:95], v14 offset:41984
    v_mfma_f32_16x16x32_bf16 v[152:155], v[124:127], v[64:67], v[152:155]
    ds_read_b128 v[96:99], v14 offset:43008
    v_mfma_f32_16x16x32_bf16 v[156:159], v[124:127], v[68:71], v[156:159]
    ds_read_b128 v[100:103], v14 offset:44032
    s_waitcnt lgkmcnt(4)
    v_mfma_f32_16x16x32_bf16 v[144:147], v[128:131], v[72:75], v[144:147]
    ds_read_b128 v[56:59], v14 offset:49152
    v_mfma_f32_16x16x32_bf16 v[148:151], v[128:131], v[76:79], v[148:151]
    ds_read_b128 v[60:63], v14 offset:50176
    v_mfma_f32_16x16x32_bf16 v[152:155], v[128:131], v[80:83], v[152:155]
    ds_read_b128 v[64:67], v14 offset:51200
    v_mfma_f32_16x16x32_bf16 v[156:159], v[128:131], v[84:87], v[156:159]
    ds_read_b128 v[68:71], v14 offset:52224
    buffer_load_dwordx4 v[24:27], v5, s[44:47], s56 offen offset:0 sc1
    s_waitcnt lgkmcnt(4)
    v_mfma_f32_16x16x32_bf16 v[144:147], v[132:135], v[88:91], v[144:147]
    ds_read_b128 v[72:75], v14 offset:57344
    v_mfma_f32_16x16x32_bf16 v[148:151], v[132:135], v[92:95], v[148:151]
    ds_read_b128 v[76:79], v14 offset:58368
    v_mfma_f32_16x16x32_bf16 v[152:155], v[132:135], v[96:99], v[152:155]
    ds_read_b128 v[80:83], v14 offset:59392
    v_mfma_f32_16x16x32_bf16 v[156:159], v[132:135], v[100:103], v[156:159]
    ds_read_b128 v[84:87], v14 offset:60416
    buffer_load_dwordx4 v[28:31], v5, s[44:47], s56 offen offset:2048 sc1
    s_setprio 2
    s_waitcnt lgkmcnt(4)
    v_mfma_f32_16x16x32_bf16 v[144:147], v[136:139], v[56:59], v[144:147]
    ds_read_b128 v[88:91], v160 offset:0
    v_mfma_f32_16x16x32_bf16 v[148:151], v[136:139], v[60:63], v[148:151]
    ds_read_b128 v[92:95], v160 offset:1024
    v_mfma_f32_16x16x32_bf16 v[152:155], v[136:139], v[64:67], v[152:155]
    ds_read_b128 v[96:99], v160 offset:2048
    v_mfma_f32_16x16x32_bf16 v[156:159], v[136:139], v[68:71], v[156:159]
    ds_read_b128 v[100:103], v160 offset:3072
    buffer_load_dwordx4 v[32:35], v5, s[44:47], s57 offen offset:0 sc1
    s_waitcnt lgkmcnt(4)
    v_mfma_f32_16x16x32_bf16 v[144:147], v[140:143], v[72:75], v[144:147]
    ds_read_b128 v[56:59], v160 offset:8192
    v_mfma_f32_16x16x32_bf16 v[148:151], v[140:143], v[76:79], v[148:151]
    ds_read_b128 v[60:63], v160 offset:9216
    v_mfma_f32_16x16x32_bf16 v[152:155], v[140:143], v[80:83], v[152:155]
    ds_read_b128 v[64:67], v160 offset:10240
    v_mfma_f32_16x16x32_bf16 v[156:159], v[140:143], v[84:87], v[156:159]
    ds_read_b128 v[68:71], v160 offset:11264
    buffer_load_dwordx4 v[36:39], v5, s[44:47], s57 offen offset:2048 sc1
L_try8:
    s_waitcnt vmcnt(3)
    v_cmp_eq_u32 vcc, -1, v24
    s_waitcnt lgkmcnt(4)
    s_cbranch_vccnz L_re8
L_go8:
    v_mfma_f32_16x16x32_bf16 v[144:147], v[24:27], v[88:91], v[144:147]
    ds_read_b128 v[72:75], v160 offset:16384
    v_mfma_f32_16x16x32_bf16 v[148:151], v[24:27], v[92:95], v[148:151]
    ds_read_b128 v[76:79], v160 offset:17408
    v_mfma_f32_16x16x32_bf16 v[152:155], v[24:27], v[96:99], v[152:155]
    ds_read_b128 v[80:83], v160 offset:18432
    v_mfma_f32_16x16x32_bf16 v[156:159], v[24:27], v[100:103], v[156:159]
    ds_read_b128 v[84:87], v160 offset:19456
    buffer_load_dwordx4 v[40:43], v5, s[44:47], s58 offen offset:0 sc1
L_try9:
    s_waitcnt vmcnt(3)
    v_cmp_eq_u32 vcc, -1, v28
    s_waitcnt lgkmcnt(4)
    s_cbranch_vccnz L_re9
L_go9:
    v_mfma_f32_16x16x32_bf16 v[144:147], v[28:31], v[56:59], v[144:147]
    ds_read_b128 v[88:91], v160 offset:24576
    v_mfma_f32_16x16x32_bf16 v[148:151], v[28:31], v[60:63], v[148:151]
    ds_read_b128 v[92:95], v160 offset:25600
    v_mfma_f32_16x16x32_bf16 v[152:155], v[28:31], v[64:67], v[152:155]
    ds_read_b128 v[96:99], v160 offset:26624
    v_mfma_f32_16x16x32_bf16 v[156:159], v[28:31], v[68:71], v[156:159]
    ds_read_b128 v[100:103], v160 offset:27648
    buffer_load_dwordx4 v[44:47], v5, s[44:47], s58 offen offset:2048 sc1
L_try10:
    s_waitcnt vmcnt(3)
    v_cmp_eq_u32 vcc, -1, v32
    s_waitcnt lgkmcnt(4)
    s_cbranch_vccnz L_re10
L_go10:
    v_mfma_f32_16x16x32_bf16 v[144:147], v[32:35], v[72:75], v[144:147]
    ds_read_b128 v[56:59], v160 offset:32768
    v_mfma_f32_16x16x32_bf16 v[148:151], v[32:35], v[76:79], v[148:151]
    ds_read_b128 v[60:63], v160 offset:33792
    v_mfma_f32_16x16x32_bf16 v[152:155], v[32:35], v[80:83], v[152:155]
    ds_read_b128 v[64:67], v160 offset:34816
    v_mfma_f32_16x16x32_bf16 v[156:159], v[32:35], v[84:87], v[156:159]
    ds_read_b128 v[68:71], v160 offset:35840
    buffer_load_dwordx4 v[48:51], v5, s[44:47], s59 offen offset:0 sc1
L_try11:
    s_waitcnt vmcnt(3)
    v_cmp_eq_u32 vcc, -1, v36
    s_waitcnt lgkmcnt(4)
    s_cbranch_vccnz L_re11
L_go11:
    s_setprio 1
    v_mfma_f32_16x16x32_bf16 v[144:147], v[36:39], v[88:91], v[144:147]
    ds_read_b128 v[72:75], v161 offset:0
    v_mfma_f32_16x16x32_bf16 v[148:151], v[36:39], v[92:95], v[148:151]
    ds_read_b128 v[76:79], v161 offset:1024
    v_mfma_f32_16x16x32_bf16 v[152:155], v[36:39], v[96:99], v[152:155]
    ds_read_b128 v[80:83], v161 offset:2048
    v_mfma_f32_16x16x32_bf16 v[156:159], v[36:39], v[100:103], v[156:159]
    ds_read_b128 v[84:87], v161 offset:3072
    buffer_load_dwordx4 v[52:55], v5, s[44:47], s59 offen offset:2048 sc1
L_try12:
    s_waitcnt vmcnt(3)
    v_cmp_eq_u32 vcc, -1, v40
    s_waitcnt lgkmcnt(4)
    s_cbranch_vccnz L_re12
L_go12:
    v_mfma_f32_16x16x32_bf16 v[144:147], v[40:43], v[56:59], v[144:147]
    ds_read_b128 v[88:91], v161 offset:8192
    v_mfma_f32_16x16x32_bf16 v[148:151], v[40:43], v[60:63], v[148:151]
    ds_read_b128 v[92:95], v161 offset:9216
    v_mfma_f32_16x16x32_bf16 v[152:155], v[40:43], v[64:67], v[152:155]
    ds_read_b128 v[96:99], v161 offset:10240
    v_mfma_f32_16x16x32_bf16 v[156:159], v[40:43], v[68:71], v[156:159]
    ds_read_b128 v[100:103], v161 offset:11264
L_try13:
    s_waitcnt vmcnt(2)
    v_cmp_eq_u32 vcc, -1, v44
    s_waitcnt lgkmcnt(4)
    s_cbranch_vccnz L_re13
L_go13:
    v_mfma_f32_16x16x32_bf16 v[144:147], v[44:47], v[72:75], v[144:147]
    ds_read_b128 v[56:59], v161 offset:16384
    v_mfma_f32_16x16x32_bf16 v[148:151], v[44:47], v[76:79], v[148:151]
    ds_read_b128 v[60:63], v161 offset:17408
    v_mfma_f32_16x16x32_bf16 v[152:155], v[44:47], v[80:83], v[152:155]
    ds_read_b128 v[64:67], v161 offset:18432
    v_mfma_f32_16x16x32_bf16 v[156:159], v[44:47], v[84:87], v[156:159]
    ds_read_b128 v[68:71], v161 offset:19456
L_try14:
    s_waitcnt vmcnt(1)
    v_cmp_eq_u32 vcc, -1, v48
    s_waitcnt lgkmcnt(4)
    s_cbranch_vccnz L_re14
L_go14:
    s_setprio 0
    v_mfma_f32_16x16x32_bf16 v[144:147], v[48:51], v[88:91], v[144:147]
    v_mfma_f32_16x16x32_bf16 v[148:151], v[48:51], v[92:95], v[148:151]
    v_mfma_f32_16x16x32_bf16 v[152:155], v[48:51], v[96:99], v[152:155]
    v_mfma_f32_16x16x32_bf16 v[156:159], v[48:51], v[100:103], v[156:159]
L_try15:
    s_waitcnt vmcnt(0)
    v_cmp_eq_u32 vcc, -1, v52
    s_waitcnt lgkmcnt(0)
    s_cbranch_vccnz L_re15
L_go15:
    v_mfma_f32_16x16x32_bf16 v[144:147], v[52:55], v[56:59], v[144:147]
    v_mfma_f32_16x16x32_bf16 v[148:151], v[52:55], v[60:63], v[148:151]
    v_mfma_f32_16x16x32_bf16 v[152:155], v[52:55], v[64:67], v[152:155]
    v_mfma_f32_16x16x32_bf16 v[156:159], v[52:55], v[68:71], v[156:159]
L_mmd:
    s_nop 4
    v_cmp_u_f32 vcc, v144, v145
    ds_write2st64_b64 v162, v[146:147], v[150:151] offset0:0 offset1:1
    v_cmp_u_f32 s[86:87], v146, v147
    ds_write2st64_b64 v162, v[154:155], v[158:159] offset0:2 offset1:3
    s_or_b64 vcc, vcc, s[86:87]
    s_cbranch_vccnz L_reB
L_goB:
    s_waitcnt lgkmcnt(0)
    s_barrier
    ds_read_b64 v[24:25], v165
    ds_read_b64 v[26:27], v165 offset:512
    ds_read_b64 v[28:29], v165 offset:1024
    ds_read_b64 v[30:31], v165 offset:1536
    s_waitcnt lgkmcnt(2)
    v_pk_add_f32 v[144:145], v[144:145], v[24:25]
    v_pk_add_f32 v[148:149], v[148:149], v[26:27]
    v_cvt_pk_bf16_f32 v40, v144, v148
    v_cvt_pk_bf16_f32 v42, v145, v149
    v_cvt_pk_bf16_f32 v44, v145, v149
    s_waitcnt lgkmcnt(0)
    v_pk_add_f32 v[152:153], v[152:153], v[28:29]
    v_pk_add_f32 v[156:157], v[156:157], v[30:31]
    v_cvt_pk_bf16_f32 v41, v152, v156
    v_cvt_pk_bf16_f32 v45, v153, v157
    v_cvt_pk_bf16_f32 v43, v153, v157
    v_mov_b32_dpp v42, v40 row_ror:8 row_mask:0xf bank_mask:0x3
    v_mov_b32_dpp v40, v44 row_ror:8 row_mask:0xf bank_mask:0xc
    v_mov_b32_dpp v43, v41 row_ror:8 row_mask:0xf bank_mask:0x3
    v_mov_b32_dpp v41, v45 row_ror:8 row_mask:0xf bank_mask:0xc
    buffer_store_dwordx4 v[40:43], v6, s[52:55], s68 offen sc1
L_end:
    s_endpgm
L_reB:
    v_max3_u32 v9, v112, v113, v114
    v_max_u32 v9, v9, v115
    v_max3_u32 v9, v9, v116, v117
    v_max3_u32 v9, v9, v118, v119
    v_max3_u32 v9, v9, v120, v121
    v_max3_u32 v9, v9, v122, v123
    v_max3_u32 v9, v9, v124, v125
    v_max3_u32 v9, v9, v126, v127
    v_max3_u32 v9, v9, v128, v129
    v_max3_u32 v9, v9, v130, v131
    v_max3_u32 v9, v9, v132, v133
    v_max3_u32 v9, v9, v134, v135
    v_max3_u32 v9, v9, v136, v137
    v_max3_u32 v9, v9, v138, v139
    v_max3_u32 v9, v9, v140, v141
    v_max3_u32 v9, v9, v142, v143
    v_max3_u32 v9, v9, v24, v25
    v_max3_u32 v9, v9, v26, v27
    v_max3_u32 v9, v9, v28, v29
    v_max3_u32 v9, v9, v30, v31
    v_max3_u32 v9, v9, v32, v33
    v_max3_u32 v9, v9, v34, v35
    v_max3_u32 v9, v9, v36, v37
    v_max3_u32 v9, v9, v38, v39
    v_max3_u32 v9, v9, v40, v41
    v_max3_u32 v9, v9, v42, v43
    v_max3_u32 v9, v9, v44, v45
    v_max3_u32 v9, v9, v46, v47
    v_max3_u32 v9, v9, v48, v49
    v_max3_u32 v9, v9, v50, v51
    v_max3_u32 v9, v9, v52, v53
    v_max3_u32 v9, v9, v54, v55
    v_cmp_eq_u32 vcc, -1, v9
    s_cmp_eq_u32 s82, 0
    s_cbranch_vccz L_goB
    s_cbranch_scc1 L_goB
    s_sub_u32 s82, s82, 1
    s_waitcnt vmcnt(0) lgkmcnt(0)
    s_add_u32 s71, s93, 4194304
    buffer_load_dwordx4 v[112:115], v5, s[44:47], s71 offen offset:0 sc1
    buffer_load_dwordx4 v[116:119], v5, s[44:47], s71 offen offset:2048 sc1
    s_add_u32 s71, s93, 4198400
    buffer_load_dwordx4 v[120:123], v5, s[44:47], s71 offen offset:0 sc1
    buffer_load_dwordx4 v[124:127], v5, s[44:47], s71 offen offset:2048 sc1
    s_add_u32 s71, s93, 4210688
    buffer_load_dwordx4 v[128:131], v5, s[44:47], s71 offen offset:0 sc1
    buffer_load_dwordx4 v[132:135], v5, s[44:47], s71 offen offset:2048 sc1
    s_add_u32 s71, s93, 4214784
    buffer_load_dwordx4 v[136:139], v5, s[44:47], s71 offen offset:0 sc1
    buffer_load_dwordx4 v[140:143], v5, s[44:47], s71 offen offset:2048 sc1
    ds_read_b128 v[56:59], v14 offset:0
    ds_read_b128 v[60:63], v14 offset:1024
    ds_read_b128 v[64:67], v14 offset:2048
    ds_read_b128 v[68:71], v14 offset:3072
    ds_read_b128 v[72:75], v14 offset:8192
    ds_read_b128 v[76:79], v14 offset:9216
    ds_read_b128 v[80:83], v14 offset:10240
    ds_read_b128 v[84:87], v14 offset:11264
    s_waitcnt vmcnt(0)
    s_branch L_okB
L_re8:
    s_cmp_eq_u32 s82, 0
    s_cbranch_scc1 L_go8
    s_sub_u32 s82, s82, 1
    s_waitcnt vmcnt(0)
    buffer_load_dwordx4 v[24:27], v5, s[44:47], s56 offen offset:0 sc1
    buffer_load_dwordx4 v[28:31], v5, s[44:47], s56 offen offset:2048 sc1
    buffer_load_dwordx4 v[32:35], v5, s[44:47], s57 offen offset:0 sc1
    buffer_load_dwordx4 v[36:39], v5, s[44:47], s57 offen offset:2048 sc1
    s_branch L_try8
L_re9:
    s_cmp_eq_u32 s82, 0
    s_cbranch_scc1 L_go9
    s_sub_u32 s82, s82, 1
    s_waitcnt vmcnt(0)
    buffer_load_dwordx4 v[28:31], v5, s[44:47], s56 offen offset:2048 sc1
    buffer_load_dwordx4 v[32:35], v5, s[44:47], s57 offen offset:0 sc1
    buffer_load_dwordx4 v[36:39], v5, s[44:47], s57 offen offset:2048 sc1
    buffer_load_dwordx4 v[40:43], v5, s[44:47], s58 offen offset:0 sc1
    s_branch L_try9
L_re10:
    s_cmp_eq_u32 s82, 0
    s_cbranch_scc1 L_go10
    s_sub_u32 s82, s82, 1
    s_waitcnt vmcnt(0)
    buffer_load_dwordx4 v[32:35], v5, s[44:47], s57 offen offset:0 sc1
    buffer_load_dwordx4 v[36:39], v5, s[44:47], s57 offen offset:2048 sc1
    buffer_load_dwordx4 v[40:43], v5, s[44:47], s58 offen offset:0 sc1
    buffer_load_dwordx4 v[44:47], v5, s[44:47], s58 offen offset:2048 sc1
    s_branch L_try10
L_re11:
    s_cmp_eq_u32 s82, 0
    s_cbranch_scc1 L_go11
    s_sub_u32 s82, s82, 1
    s_waitcnt vmcnt(0)
    buffer_load_dwordx4 v[36:39], v5, s[44:47], s57 offen offset:2048 sc1
    buffer_load_dwordx4 v[40:43], v5, s[44:47], s58 offen offset:0 sc1
    buffer_load_dwordx4 v[44:47], v5, s[44:47], s58 offen offset:2048 sc1
    buffer_load_dwordx4 v[48:51], v5, s[44:47], s59 offen offset:0 sc1
    s_branch L_try11
L_re12:
    s_cmp_eq_u32 s82, 0
    s_cbranch_scc1 L_go12
    s_sub_u32 s82, s82, 1
    s_waitcnt vmcnt(0)
    buffer_load_dwordx4 v[40:43], v5, s[44:47], s58 offen offset:0 sc1
    buffer_load_dwordx4 v[44:47], v5, s[44:47], s58 offen offset:2048 sc1
    buffer_load_dwordx4 v[48:51], v5, s[44:47], s59 offen offset:0 sc1
    buffer_load_dwordx4 v[52:55], v5, s[44:47], s59 offen offset:2048 sc1
    s_branch L_try12
L_re13:
    s_cmp_eq_u32 s82, 0
    s_cbranch_scc1 L_go13
    s_sub_u32 s82, s82, 1
    s_waitcnt vmcnt(0)
    buffer_load_dwordx4 v[44:47], v5, s[44:47], s58 offen offset:2048 sc1
    buffer_load_dwordx4 v[48:51], v5, s[44:47], s59 offen offset:0 sc1
    buffer_load_dwordx4 v[52:55], v5, s[44:47], s59 offen offset:2048 sc1
    s_branch L_try13
L_re14:
    s_cmp_eq_u32 s82, 0
    s_cbranch_scc1 L_go14
    s_sub_u32 s82, s82, 1
    s_waitcnt vmcnt(0)
    buffer_load_dwordx4 v[48:51], v5, s[44:47], s59 offen offset:0 sc1
    buffer_load_dwordx4 v[52:55], v5, s[44:47], s59 offen offset:2048 sc1
    s_branch L_try14
L_re15:
    s_cmp_eq_u32 s82, 0
    s_cbranch_scc1 L_go15
    s_sub_u32 s82, s82, 1
    s_waitcnt vmcnt(0)
    buffer_load_dwordx4 v[52:55], v5, s[44:47], s59 offen offset:2048 sc1
    s_branch L_try15
L_spin_kv:
    s_mov_b32 s82, 4194304
L_spin2_kv:
    ds_read_b32 v164, v163 offset:20
    s_sub_u32 s82, s82, 1
    s_cmp_eq_u32 s82, 0
    s_cbranch_scc1 L_ok_kv
    s_waitcnt lgkmcnt(0)
    v_readfirstlane_b32 s73, v164
    s_nop 0
    s_cmp_lt_u32 s73, 4
    s_cbranch_scc1 L_spin2_kv
    s_branch L_ok_kv
L_spin_kv2:
    s_mov_b32 s82, 4194304
L_spin2_kv2:
    ds_read_b32 v164, v163 offset:24
    s_sub_u32 s82, s82, 1
    s_cmp_eq_u32 s82, 0
    s_cbranch_scc1 L_ok_kv2
    s_waitcnt lgkmcnt(0)
    v_readfirstlane_b32 s73, v164
    s_nop 0
    s_cmp_lt_u32 s73, 4
    s_cbranch_scc1 L_spin2_kv2
    s_branch L_ok_kv2
L_spin_s2:
    s_mov_b32 s82, 4194304
L_spin2_s2:
    ds_read_b32 v164, v163 offset:0
    s_sub_u32 s82, s82, 1
    s_cmp_eq_u32 s82, 0
    s_cbranch_scc1 L_ok_s2
    s_waitcnt lgkmcnt(0)
    v_readfirstlane_b32 s73, v164
    s_nop 0
    s_cmp_lt_u32 s73, 288
    s_cbranch_scc1 L_spin2_s2
    s_branch L_ok_s2
L_spin_w:
    s_mov_b32 s82, 4194304
L_spin2_w:
    ds_read_b32 v164, v163 offset:16
    s_sub_u32 s82, s82, 1
    s_cmp_eq_u32 s82, 0
    s_cbranch_scc1 L_ok_w
    s_waitcnt lgkmcnt(0)
    v_readfirstlane_b32 s73, v164
    s_nop 0
    s_cmp_lt_u32 s73, 4
    s_cbranch_scc1 L_spin2_w
    s_branch L_ok_w
L_fallback:
    v_mov_b32 v10, 0xff800000
    v_mov_b32 v11, 0xff800000
    s_mov_b32 s71, 0
L_fb1:
    buffer_load_dwordx4 v[88:91], v1, s[44:47], s71 offen sc1
    s_waitcnt vmcnt(0)
    v_mfma_f32_32x32x16_bf16 v[56:71], v[88:91], v[16:19], 0
    s_nop 11
    v_max3_f32 v10, v10, v56, v57
    v_max3_f32 v11, v11, v58, v59
    v_max3_f32 v10, v10, v60, v61
    v_max3_f32 v11, v11, v62, v63
    v_max3_f32 v10, v10, v64, v65
    v_max3_f32 v11, v11, v66, v67
    v_max3_f32 v10, v10, v68, v69
    v_max3_f32 v11, v11, v70, v71
    s_add_u32 s71, s71, 2048
    s_cmp_lt_u32 s71, 131072
    s_cbranch_scc1 L_fb1
    v_max_f32 v10, v10, v11
    v_mov_b32 v11, v10
    s_nop 1
    v_permlane32_swap_b32 v10, v11
    v_max_f32 v10, v10, v11
    v_sub_f32 v24, 0x80000000, v10
    v_mov_b32 v25, v24
    v_mov_b64 v[26:27], v[24:25]
    v_mov_b64 v[28:29], v[24:25]
    v_mov_b64 v[30:31], v[24:25]
    v_mov_b64 v[32:33], v[24:25]
    v_mov_b64 v[34:35], v[24:25]
    v_mov_b64 v[36:37], v[24:25]
    v_mov_b64 v[38:39], v[24:25]
    v_mov_b64 v[40:41], 0
    v_mov_b64 v[42:43], 0
    v_mov_b64 v[44:45], 0
    v_mov_b64 v[46:47], 0
    v_mov_b64 v[48:49], 0
    v_mov_b64 v[50:51], 0
    v_mov_b64 v[52:53], 0
    v_mov_b64 v[54:55], 0
    s_mov_b32 s71, 0
L_fb2:
    buffer_load_dwordx4 v[88:91], v1, s[44:47], s71 offen sc1
    s_mov_b64 exec, s[80:81]
    buffer_load_dwordx4 v[96:99], v1, s[44:47], s71 offen offset:1024 sc1
    buffer_load_dwordx4 v[100:103], v1, s[44:47], s71 offen offset:1280 sc1
    s_mov_b64 exec, -1
    s_waitcnt vmcnt(0)
    v_mfma_f32_32x32x16_bf16 v[56:71], v[88:91], v[16:19], v[24:39]
    s_nop 11
    v_exp_f32 v56, v56
    v_exp_f32 v57, v57
    v_exp_f32 v58, v58
    v_exp_f32 v59, v59
    v_exp_f32 v60, v60
    v_exp_f32 v61, v61
    v_exp_f32 v62, v62
    v_exp_f32 v63, v63
    v_exp_f32 v64, v64
    v_exp_f32 v65, v65
    v_exp_f32 v66, v66
    v_exp_f32 v67, v67
    v_exp_f32 v68, v68
    v_exp_f32 v69, v69
    v_exp_f32 v70, v70
    v_exp_f32 v71, v71
    s_nop 1
    v_smfmac_f32_32x32x32_bf16 v[40:55], v[96:99], v[56:63], v3
    v_smfmac_f32_32x32x32_bf16 v[40:55], v[100:103], v[64:71], v3
    s_add_u32 s71, s71, 2048
    s_cmp_lt_u32 s71, 131072
    s_nop 7
    s_cbranch_scc1 L_fb2
    s_nop 15
    v_rcp_f32 v10, v48
    s_add_u32 s71, s83, 2097152
    v_mul_f32 v10, v10, v8
    s_branch L_norm
.p2align 6
L_helper:
    s_sub_u32 s70, s3, 8
    s_add_u32 s66, s74, s73
    s_and_b32 s66, s66, 3
    s_or_b32 s66, s66, s87
    s_lshr_b32 s79, s86, 1
    s_add_u32 s79, s79, s3
    s_add_u32 s79, s79, 1
    s_and_b32 s79, s79, 3
    s_lshl2_add_u32 s79, s64, s79
    s_lshl_b32 s79, s79, 14
    v_add_u32 v16, s79, v10
    v_xor_b32 v17, 64, v16
    v_add_u32 v17, 7168, v17
    s_max_u32 s71, s70, 1
    s_sub_u32 s71, s71, 1
    s_lshl_b32 s72, s70, 2
    s_lshr_b32 s72, 8720, s72
    s_and_b32 s72, s72, 7
    s_xor_b32 s72, s72, s65
    s_lshl3_add_u32 s71, s71, s72
    s_lshl_b32 s71, s71, 7
    s_lshl_b32 s92, s70, 11
    s_lshl_b32 s93, s70, 13
    s_mov_b32 s35, 0x20000
    s_cmp_eq_u32 s70, 0
    s_cselect_b32 s78, 1, 3
    s_lshl_b32 s34, s78, 19
    s_lshl_b32 s67, s78, 15
    s_lshl_b32 s78, s78, 10
    v_bfe_u32 v9, v6, 4, 1
    v_lshlrev_b32 v9, 1, v9
    v_xor_b32 v9, v9, v11
    v_lshl_add_u32 v9, v9, 4, s71
    v_mad_u32_u24 v18, v12, s78, v9
    s_lshl_b32 s72, s78, 3
    s_sub_u32 s72, s72, 1024
    v_xor_b32 v19, 64, v18
    v_add_u32 v19, s72, v19
    s_lshl_b32 s72, s72, 1
    v_add_u32 v20, s72, v18
    v_add_u32 v21, s72, v19
    s_cmp_eq_u32 s70, 3
    s_cselect_b64 vcc, 1, 0
    s_cmp_eq_u32 s70, 0
    s_waitcnt lgkmcnt(0)
    s_cselect_b32 s32, s6, s16
    s_cselect_b32 s33, s7, s17
    s_mov_b32 s28, s4
    s_mov_b32 s29, s5
    s_lshl_b32 s68, s66, 7
    s_add_u32 m0, s92, 40960
    s_lshl_b32 s69, s66, 1
    s_cbranch_vccnz L_cy0
    buffer_load_dwordx4 v16, s[28:31], s68 offen  lds
    buffer_load_dwordx4 v17, s[28:31], s68 offen offset:1024  lds
L_cy0:
    s_add_u32 m0, s93, 49152
    s_mul_i32 s69, s69, s67
    buffer_load_dwordx4 v18, s[32:35], s69 offen offset:0  lds
    buffer_load_dwordx4 v19, s[32:35], s69 offen offset:1024  lds
    buffer_load_dwordx4 v20, s[32:35], s69 offen offset:2048  lds
    buffer_load_dwordx4 v21, s[32:35], s69 offen offset:3072  lds
    s_add_u32 m0, s93, 53248
    s_add_u32 s69, s69, s67
    buffer_load_dwordx4 v18, s[32:35], s69 offen offset:0  lds
    buffer_load_dwordx4 v19, s[32:35], s69 offen offset:1024  lds
    buffer_load_dwordx4 v20, s[32:35], s69 offen offset:2048  lds
    buffer_load_dwordx4 v21, s[32:35], s69 offen offset:3072  lds
    s_add_u32 s66, s66, 1
    s_and_b32 s66, s66, 3
    s_or_b32 s66, s66, s87
    v_mov_b32 v163, 163776
    v_mov_b64 v[28:29], 0
    v_mov_b64 v[30:31], 0
    ds_write_b128 v163, v[28:31]
    ds_write_b128 v163, v[28:31] offset:16
    s_xor_b32 s100, s65, 2
    s_xor_b32 s101, s65, 1
    s_mov_b32 s44, s26
    s_mov_b32 s45, s27
    s_mov_b32 s46, 8388608
    s_mov_b32 s47, 0x20000
    s_mov_b32 s48, s24
    s_mov_b32 s49, s25
    s_mov_b32 s50, 256
    s_mov_b32 s51, 0x20000
    s_bitcmp1_b32 s2, 4
    s_cselect_b32 s56, s12, s18
    s_cselect_b32 s57, s13, s19
    s_mov_b32 s58, 524288
    s_mov_b32 s59, 0x20000
    s_lshl_b32 s68, s66, 7
    s_add_u32 m0, s92, 81920
    s_lshl_b32 s69, s66, 1
    s_cbranch_vccnz L_cy1
    buffer_load_dwordx4 v16, s[28:31], s68 offen  lds
    buffer_load_dwordx4 v17, s[28:31], s68 offen offset:1024  lds
L_cy1:
    s_add_u32 m0, s93, 90112
    s_mul_i32 s69, s69, s67
    buffer_load_dwordx4 v18, s[32:35], s69 offen offset:0  lds
    buffer_load_dwordx4 v19, s[32:35], s69 offen offset:1024  lds
    buffer_load_dwordx4 v20, s[32:35], s69 offen offset:2048  lds
    buffer_load_dwordx4 v21, s[32:35], s69 offen offset:3072  lds
    s_add_u32 m0, s93, 94208
    s_add_u32 s69, s69, s67
    buffer_load_dwordx4 v18, s[32:35], s69 offen offset:0  lds
    buffer_load_dwordx4 v19, s[32:35], s69 offen offset:1024  lds
    buffer_load_dwordx4 v20, s[32:35], s69 offen offset:2048  lds
    buffer_load_dwordx4 v21, s[32:35], s69 offen offset:3072  lds
    s_add_u32 s66, s66, 1
    s_and_b32 s66, s66, 3
    s_or_b32 s66, s66, s87
    v_lshrrev_b32 v24, 1, v6
    v_lshlrev_b32 v24, 8, v24
    v_and_b32 v22, 1, v6
    v_lshl_add_u32 v24, v22, 4, v24
    v_add_u32 v24, 1310720, v24
    s_mul_i32 s71, s70, 1088
    s_add_u32 s71, s71, 131072
    v_add_u32 v26, s71, v1
    v_and_b32 v22, 31, v6
    v_lshlrev_b32 v104, 2, v22
    v_lshrrev_b32 v23, 5, v6
    v_mul_u32_u24 v105, 69632, v23
    v_lshl_add_u32 v105, v22, 3, v105
    v_lshl_add_u32 v22, v23, 2, v12
    v_lshlrev_b32 v107, 4, v11
    v_lshl_add_u32 v107, v22, 10, v107
    s_lshl_b32 s71, s70, 10
    s_add_u32 s71, s71, 151552
    v_bfe_u32 v22, v6, 2, 2
    v_lshl_add_u32 v22, v22, 2, v8
    v_and_b32 v23, 3, v6
    v_lshl_add_u32 v22, v22, 2, v23
    v_lshl_add_u32 v108, v22, 3, s71
    v_lshlrev_b32 v23, 1, v23
    v_bfe_u32 v22, v6, 2, 1
    v_add_u32 v22, v22, v23
    v_lshl_add_u32 v22, v22, 3, v12
    v_lshl_add_u32 v110, v22, 4, s71
    v_add_u32 v111, s71, v1
    v_and_b32 v22, 15, v6
    v_lshlrev_b32 v22, 4, v22
    v_lshl_add_u32 v120, v8, 10, v22
    s_lshl_b32 s71, s101, 10
    s_add_u32 s71, s71, 1310720
    v_and_b32 v109, 0x3ff, v24
    v_add_u32 v109, s71, v109
    v_mov_b32 v10, 1
    v_mov_b32 v14, 16
    v_mov_b32 v13, 64
    v_min_u32 v121, 16, v6
    v_lshlrev_b32 v121, 7, v121
    s_waitcnt vmcnt(10) lgkmcnt(0)
    s_cbranch_vccz L_w9
    s_waitcnt vmcnt(8)
L_w9:
    v_mov_b64 v[28:29], -1
    v_mov_b64 v[30:31], -1
    s_barrier
    s_lshl_b32 s68, s66, 7
    s_add_u32 m0, s92, 0
    s_lshl_b32 s69, s66, 1
    s_cbranch_vccnz L_cy2
    buffer_load_dwordx4 v16, s[28:31], s68 offen  lds
    buffer_load_dwordx4 v17, s[28:31], s68 offen offset:1024  lds
L_cy2:
    s_add_u32 m0, s93, 8192
    s_mul_i32 s69, s69, s67
    buffer_load_dwordx4 v18, s[32:35], s69 offen offset:0  lds
    buffer_load_dwordx4 v19, s[32:35], s69 offen offset:1024  lds
    buffer_load_dwordx4 v20, s[32:35], s69 offen offset:2048  lds
    buffer_load_dwordx4 v21, s[32:35], s69 offen offset:3072  lds
    s_add_u32 m0, s93, 12288
    s_add_u32 s69, s69, s67
    buffer_load_dwordx4 v18, s[32:35], s69 offen offset:0  lds
    buffer_load_dwordx4 v19, s[32:35], s69 offen offset:1024  lds
    buffer_load_dwordx4 v20, s[32:35], s69 offen offset:2048  lds
    buffer_load_dwordx4 v21, s[32:35], s69 offen offset:3072  lds
    s_add_u32 s66, s66, 1
    s_and_b32 s66, s66, 3
    s_or_b32 s66, s66, s87
    s_waitcnt vmcnt(10)
    s_cbranch_vccz L_w0
    s_waitcnt vmcnt(8)
L_w0:
    s_barrier
    s_lshl_b32 s68, s66, 7
    s_add_u32 m0, s92, 40960
    s_lshl_b32 s69, s66, 1
    s_cbranch_vccnz L_cy3
    buffer_load_dwordx4 v16, s[28:31], s68 offen  lds
    buffer_load_dwordx4 v17, s[28:31], s68 offen offset:1024  lds
L_cy3:
    s_add_u32 m0, s93, 49152
    s_mul_i32 s69, s69, s67
    buffer_load_dwordx4 v18, s[32:35], s69 offen offset:0  lds
    buffer_load_dwordx4 v19, s[32:35], s69 offen offset:1024  lds
    buffer_load_dwordx4 v20, s[32:35], s69 offen offset:2048  lds
    buffer_load_dwordx4 v21, s[32:35], s69 offen offset:3072  lds
    s_add_u32 m0, s93, 53248
    s_add_u32 s69, s69, s67
    buffer_load_dwordx4 v18, s[32:35], s69 offen offset:0  lds
    buffer_load_dwordx4 v19, s[32:35], s69 offen offset:1024  lds
    buffer_load_dwordx4 v20, s[32:35], s69 offen offset:2048  lds
    buffer_load_dwordx4 v21, s[32:35], s69 offen offset:3072  lds
    s_add_u32 s66, s66, 1
    s_and_b32 s66, s66, 3
    s_add_u32 s87, s87, 4
    s_and_b32 s87, s87, 7
    s_or_b32 s66, s66, s87
    s_waitcnt vmcnt(10)
    s_cbranch_vccz L_w1
    s_waitcnt vmcnt(8)
L_w1:
    s_barrier
    s_lshl_b32 s68, s66, 7
    s_add_u32 m0, s92, 81920
    s_lshl_b32 s69, s66, 1
    s_cbranch_vccnz L_cy4
    buffer_load_dwordx4 v16, s[28:31], s68 offen  lds
    buffer_load_dwordx4 v17, s[28:31], s68 offen offset:1024  lds
L_cy4:
    s_add_u32 m0, s93, 90112
    s_mul_i32 s69, s69, s67
    buffer_load_dwordx4 v18, s[32:35], s69 offen offset:0  lds
    buffer_load_dwordx4 v19, s[32:35], s69 offen offset:1024  lds
    buffer_load_dwordx4 v20, s[32:35], s69 offen offset:2048  lds
    buffer_load_dwordx4 v21, s[32:35], s69 offen offset:3072  lds
    s_add_u32 m0, s93, 94208
    s_add_u32 s69, s69, s67
    buffer_load_dwordx4 v18, s[32:35], s69 offen offset:0  lds
    buffer_load_dwordx4 v19, s[32:35], s69 offen offset:1024  lds
    buffer_load_dwordx4 v20, s[32:35], s69 offen offset:2048  lds
    buffer_load_dwordx4 v21, s[32:35], s69 offen offset:3072  lds
    s_add_u32 s66, s66, 1
    s_and_b32 s66, s66, 3
    s_or_b32 s66, s66, s87
    s_waitcnt vmcnt(10)
    s_cbranch_vccz L_w2
    s_waitcnt vmcnt(8)
L_w2:
    s_barrier
    s_lshl_b32 s68, s66, 7
    s_add_u32 m0, s92, 0
    s_lshl_b32 s69, s66, 1
    s_cbranch_vccnz L_cy5
    buffer_load_dwordx4 v16, s[28:31], s68 offen  lds
    buffer_load_dwordx4 v17, s[28:31], s68 offen offset:1024  lds
L_cy5:
    s_add_u32 m0, s93, 8192
    s_mul_i32 s69, s69, s67
    buffer_load_dwordx4 v18, s[32:35], s69 offen offset:0  lds
    buffer_load_dwordx4 v19, s[32:35], s69 offen offset:1024  lds
    buffer_load_dwordx4 v20, s[32:35], s69 offen offset:2048  lds
    buffer_load_dwordx4 v21, s[32:35], s69 offen offset:3072  lds
    s_add_u32 m0, s93, 12288
    s_add_u32 s69, s69, s67
    buffer_load_dwordx4 v18, s[32:35], s69 offen offset:0  lds
    buffer_load_dwordx4 v19, s[32:35], s69 offen offset:1024  lds
    buffer_load_dwordx4 v20, s[32:35], s69 offen offset:2048  lds
    buffer_load_dwordx4 v21, s[32:35], s69 offen offset:3072  lds
    s_add_u32 s66, s66, 1
    s_and_b32 s66, s66, 3
    s_or_b32 s66, s66, s87
    s_waitcnt vmcnt(10)
    s_cbranch_vccz L_w3
    s_waitcnt vmcnt(8)
L_w3:
    s_barrier
    s_lshl_b32 s68, s66, 7
    s_add_u32 m0, s92, 40960
    s_lshl_b32 s69, s66, 1
    s_cbranch_vccnz L_cy6
    buffer_load_dwordx4 v16, s[28:31], s68 offen  lds
    buffer_load_dwordx4 v17, s[28:31], s68 offen offset:1024  lds
L_cy6:
    s_add_u32 m0, s93, 49152
    s_mul_i32 s69, s69, s67
    buffer_load_dwordx4 v18, s[32:35], s69 offen offset:0  lds
    buffer_load_dwordx4 v19, s[32:35], s69 offen offset:1024  lds
    buffer_load_dwordx4 v20, s[32:35], s69 offen offset:2048  lds
    buffer_load_dwordx4 v21, s[32:35], s69 offen offset:3072  lds
    s_add_u32 m0, s93, 53248
    s_add_u32 s69, s69, s67
    buffer_load_dwordx4 v18, s[32:35], s69 offen offset:0  lds
    buffer_load_dwordx4 v19, s[32:35], s69 offen offset:1024  lds
    buffer_load_dwordx4 v20, s[32:35], s69 offen offset:2048  lds
    buffer_load_dwordx4 v21, s[32:35], s69 offen offset:3072  lds
    s_add_u32 s66, s66, 1
    s_and_b32 s66, s66, 3
    s_or_b32 s66, s66, s87
    s_waitcnt vmcnt(10)
    s_cbranch_vccz L_w4
    s_waitcnt vmcnt(8)
L_w4:
    s_barrier
    s_lshl_b32 s68, s66, 7
    s_add_u32 m0, s92, 81920
    s_lshl_b32 s69, s66, 1
    s_cbranch_vccnz L_cy7
    buffer_load_dwordx4 v16, s[28:31], s68 offen  lds
    buffer_load_dwordx4 v17, s[28:31], s68 offen offset:1024  lds
L_cy7:
    s_add_u32 m0, s93, 90112
    s_mul_i32 s69, s69, s67
    buffer_load_dwordx4 v18, s[32:35], s69 offen offset:0  lds
    buffer_load_dwordx4 v19, s[32:35], s69 offen offset:1024  lds
    buffer_load_dwordx4 v20, s[32:35], s69 offen offset:2048  lds
    buffer_load_dwordx4 v21, s[32:35], s69 offen offset:3072  lds
    s_add_u32 m0, s93, 94208
    s_add_u32 s69, s69, s67
    buffer_load_dwordx4 v18, s[32:35], s69 offen offset:0  lds
    buffer_load_dwordx4 v19, s[32:35], s69 offen offset:1024  lds
    buffer_load_dwordx4 v20, s[32:35], s69 offen offset:2048  lds
    buffer_load_dwordx4 v21, s[32:35], s69 offen offset:3072  lds
    s_add_u32 s66, s66, 1
    s_and_b32 s66, s66, 3
    s_add_u32 s87, s87, 4
    s_and_b32 s87, s87, 7
    s_or_b32 s66, s66, s87
    s_waitcnt vmcnt(10)
    s_cbranch_vccz L_w5
    s_waitcnt vmcnt(8)
L_w5:
    s_barrier
    buffer_load_dwordx4 v[100:103], v24, s[44:47], 0 offen sc1
    s_waitcnt vmcnt(1)
    s_barrier
    s_setprio 3
    s_mov_b32 s82, 262144
    s_branch L_gc_s1
L_gp_s1:
    s_sleep 2
L_gf_s1:
    buffer_load_dwordx4 v[100:103], v24, s[44:47], 0 offen offset:0 sc1
    s_sub_u32 s82, s82, 1
    s_cmp_eq_u32 s82, 0
    s_cbranch_scc1 L_gd_s1
L_gc_s1:
    s_waitcnt vmcnt(0)
    v_min3_u32 v25, v100, v101, v102
    v_min_u32 v25, v25, v103
    v_cmp_gt_u32 vcc, 1, v25
    s_nop 0
    s_cbranch_vccnz L_gp_s1
L_gd_s1:
    s_lshl_b32 s79, s70, 12
    s_add_u32 s71, s79, 0
    s_mov_b32 m0, s71
    s_nop 0
    buffer_load_dwordx4 v1, s[44:47], s71 offen offset:0 sc1 lds
    buffer_load_dwordx4 v1, s[44:47], s71 offen offset:1024 sc1 lds
    buffer_load_dwordx4 v1, s[44:47], s71 offen offset:2048 sc1 lds
    buffer_load_dwordx4 v1, s[44:47], s71 offen offset:3072 sc1 lds
    s_add_u32 s71, s79, 16384
    s_mov_b32 m0, s71
    s_nop 0
    buffer_load_dwordx4 v1, s[44:47], s71 offen offset:0 sc1 lds
    buffer_load_dwordx4 v1, s[44:47], s71 offen offset:1024 sc1 lds
    buffer_load_dwordx4 v1, s[44:47], s71 offen offset:2048 sc1 lds
    buffer_load_dwordx4 v1, s[44:47], s71 offen offset:3072 sc1 lds
    s_waitcnt vmcnt(0)
    s_barrier
    s_and_b32 s71, s2, 1
    s_lshl_b32 s71, s71, 2
    s_bfe_u32 s72, s2, 131073
    s_add_u32 s71, s71, s72
    s_and_b32 s72, s2, 8
    s_add_u32 s71, s71, s72
    s_lshr_b32 s72, s70, 1
    s_lshl1_add_u32 s71, s71, s72
    s_and_b32 s72, s70, 1
    s_lshl2_add_u32 s71, s71, s72
    s_lshl_b32 s71, s71, 5
    s_lshr_b32 s72, s2, 5
    s_add_u32 s71, s71, s72
    s_lshl_b32 s72, s70, 10
    s_add_u32 m0, s72, 151552
    s_lshl_b32 s71, s71, 7
    buffer_load_dwordx4 v107, s[56:59], s71 offen lds
    s_and_b32 s71, s2, 0xf8
    s_lshl_b32 s71, s71, 9
    s_lshl_b32 s72, s70, 10
    s_add_u32 s71, s71, s72
    buffer_load_dwordx4 v[100:103], v1, s[44:47], s71 offen sc1
    s_add_u32 s71, s79, 32768
    s_mov_b32 m0, s71
    s_nop 0
    s_waitcnt vmcnt(2)
    buffer_load_dwordx4 v1, s[44:47], s71 offen offset:0 sc1 lds
    s_waitcnt vmcnt(2)
    buffer_load_dwordx4 v1, s[44:47], s71 offen offset:1024 sc1 lds
    s_waitcnt vmcnt(2)
    buffer_load_dwordx4 v1, s[44:47], s71 offen offset:2048 sc1 lds
    s_waitcnt vmcnt(2)
    buffer_load_dwordx4 v1, s[44:47], s71 offen offset:3072 sc1 lds
    s_add_u32 s71, s79, 49152
    s_mov_b32 m0, s71
    s_nop 0
    s_waitcnt vmcnt(2)
    buffer_load_dwordx4 v1, s[44:47], s71 offen offset:0 sc1 lds
    s_waitcnt vmcnt(2)
    buffer_load_dwordx4 v1, s[44:47], s71 offen offset:1024 sc1 lds
    s_waitcnt vmcnt(2)
    buffer_load_dwordx4 v1, s[44:47], s71 offen offset:2048 sc1 lds
    s_waitcnt vmcnt(2)
    buffer_load_dwordx4 v1, s[44:47], s71 offen offset:3072 sc1 lds
    s_waitcnt vmcnt(0)
    s_mov_b32 s82, 1048576
    s_branch L_lq_ep
L_lp_ep:
    s_sleep 4
L_lq_ep:
    ds_read_b32 v9, v163 offset:28
    s_sub_u32 s82, s82, 1
    s_cmp_eq_u32 s82, 0
    s_cbranch_scc1 L_lp_epd
    s_waitcnt lgkmcnt(0)
    v_readfirstlane_b32 s72, v9
    s_nop 0
    s_cmp_lt_u32 s72, 8
    s_cbranch_scc1 L_lp_ep
L_lp_epd:
    ds_read_b128 v[40:43], v26
    ds_read_b128 v[48:51], v26 offset:1024
    s_mov_b64 exec, 1
    s_waitcnt vmcnt(0)
    ds_add_u32 v163, v10 offset:20
    s_mov_b64 exec, -1
    s_lshl_b32 s71, s64, 6
    s_lshl2_add_u32 s72, s65, s70
    s_add_u32 s71, s71, s72
    s_lshl_b32 s83, s71, 10
    s_add_u32 s71, s83, 2097152
    buffer_store_dwordx4 v[28:31], v1, s[44:47], s71 offen sc1
    s_add_u32 s71, s83, 2129920
    buffer_store_dwordx4 v[28:31], v1, s[44:47], s71 offen sc1
    s_xor_b32 s83, s83, 4096
    s_add_u32 s71, s83, 4194304
    buffer_store_dwordx4 v[28:31], v1, s[44:47], s71 offen sc1
    s_add_u32 s71, s83, 4227072
    buffer_store_dwordx4 v[28:31], v1, s[44:47], s71 offen sc1
    s_lshl_b32 s71, s100, 5
    s_add_u32 s71, s71, s64
    s_lshl2_add_u32 s71, s71, s70
    s_mul_i32 s71, s71, 1088
    s_add_u32 s71, s71, 163840
    s_waitcnt lgkmcnt(0)
    buffer_store_dwordx4 v[40:43], v1, s[44:47], s71 offen sc1
    s_mov_b64 exec, 15
    buffer_store_dwordx4 v[48:51], v1, s[44:47], s71 offen offset:1024 sc1
    s_mov_b64 exec, -1
    ds_read_b64_tr_b16 v[64:65], v108
    ds_read_b64_tr_b16 v[66:67], v108 offset:512
    s_lshl4_add_u32 s71, s2, s70
    s_lshl_b32 s71, s71, 8
    s_add_u32 s71, s71, 7340032
    s_waitcnt lgkmcnt(0)
    ds_write_b128 v110, v[64:67]
    s_waitcnt lgkmcnt(0)
    ds_read_b128 v[64:67], v111
    s_waitcnt lgkmcnt(0)
    buffer_store_dwordx4 v[64:67], v120, s[44:47], s71 offen sc1
    s_mov_b64 exec, 1
    s_waitcnt vmcnt(0)
    ds_add_rtn_u32 v12, v163, v10
    s_lshr_b32 s71, s2, 3
    s_lshl_b32 s71, s71, 8
    s_and_b32 s72, s2, 7
    s_lshl2_add_u32 s71, s72, s71
    s_add_u32 s71, s71, 1310720
    s_waitcnt lgkmcnt(0)
    v_readfirstlane_b32 s72, v12
    s_nop 0
    s_and_b32 s72, s72, 7
    s_cmp_eq_u32 s72, 3
    s_cbranch_scc0 L_nosig2
    buffer_store_dword v10, off, s[44:47], s71 offset:128 sc1
L_nosig2:
    s_mov_b64 exec, -1
    s_add_u32 s71, s79, 65536
    s_mov_b32 m0, s71
    s_nop 0
    s_waitcnt vmcnt(2)
    buffer_load_dwordx4 v1, s[44:47], s71 offen offset:0 sc1 lds
    s_waitcnt vmcnt(2)
    buffer_load_dwordx4 v1, s[44:47], s71 offen offset:1024 sc1 lds
    s_waitcnt vmcnt(2)
    buffer_load_dwordx4 v1, s[44:47], s71 offen offset:2048 sc1 lds
    s_waitcnt vmcnt(2)
    buffer_load_dwordx4 v1, s[44:47], s71 offen offset:3072 sc1 lds
    s_add_u32 s71, s79, 81920
    s_mov_b32 m0, s71
    s_nop 0
    s_waitcnt vmcnt(2)
    buffer_load_dwordx4 v1, s[44:47], s71 offen offset:0 sc1 lds
    s_waitcnt vmcnt(2)
    buffer_load_dwordx4 v1, s[44:47], s71 offen offset:1024 sc1 lds
    s_waitcnt vmcnt(2)
    buffer_load_dwordx4 v1, s[44:47], s71 offen offset:2048 sc1 lds
    s_waitcnt vmcnt(2)
    buffer_load_dwordx4 v1, s[44:47], s71 offen offset:3072 sc1 lds
    s_mov_b64 exec, 1
    s_waitcnt vmcnt(0)
    ds_add_u32 v163, v10 offset:24
    s_mov_b64 exec, -1
    s_cmp_eq_u32 s70, 0
    s_cbranch_scc0 L_nol1
    s_mov_b32 s82, 262144
L_gp_s2:
    s_sleep 12
L_gf_s2:
    buffer_load_dwordx4 v[100:103], v24, s[44:47], 0 offen offset:128 sc1
    s_sub_u32 s82, s82, 1
    s_cmp_eq_u32 s82, 0
    s_cbranch_scc1 L_gd_s2
L_gc_s2:
    s_waitcnt vmcnt(0)
    v_min3_u32 v25, v100, v101, v102
    v_min_u32 v25, v25, v103
    v_cmp_gt_u32 vcc, 1, v25
    s_nop 0
    s_cbranch_vccnz L_gp_s2
L_gd_s2:
    s_mov_b64 exec, 1
    ds_add_u32 v163, v14
    s_mov_b32 exec_lo, 0x1ffff
    s_mov_b32 exec_hi, 0x1ffff
    s_mul_i32 s71, s100, 139264
    s_mul_i32 s72, s64, 136
    s_add_u32 s71, s71, s72
    s_add_u32 s71, s71, 163840
    buffer_load_dwordx2 v[64:65], v105, s[44:47], s71 offen sc1
    s_add_u32 s71, s71, 4352
    buffer_load_dwordx2 v[66:67], v105, s[44:47], s71 offen sc1
    s_add_u32 s71, s71, 4352
    buffer_load_dwordx2 v[68:69], v105, s[44:47], s71 offen sc1
    s_add_u32 s71, s71, 4352
    buffer_load_dwordx2 v[70:71], v105, s[44:47], s71 offen sc1
    s_add_u32 s71, s71, 4352
    buffer_load_dwordx2 v[72:73], v105, s[44:47], s71 offen sc1
    s_add_u32 s71, s71, 4352
    buffer_load_dwordx2 v[74:75], v105, s[44:47], s71 offen sc1
    s_add_u32 s71, s71, 4352
    buffer_load_dwordx2 v[76:77], v105, s[44:47], s71 offen sc1
    s_add_u32 s71, s71, 4352
    buffer_load_dwordx2 v[78:79], v105, s[44:47], s71 offen sc1
    s_add_u32 s71, s71, 4352
    buffer_load_dwordx2 v[80:81], v105, s[44:47], s71 offen sc1
    s_add_u32 s71, s71, 4352
    buffer_load_dwordx2 v[82:83], v105, s[44:47], s71 offen sc1
    s_add_u32 s71, s71, 4352
    buffer_load_dwordx2 v[84:85], v105, s[44:47], s71 offen sc1
    s_add_u32 s71, s71, 4352
    buffer_load_dwordx2 v[86:87], v105, s[44:47], s71 offen sc1
    s_add_u32 s71, s71, 4352
    buffer_load_dwordx2 v[88:89], v105, s[44:47], s71 offen sc1
    s_add_u32 s71, s71, 4352
    buffer_load_dwordx2 v[90:91], v105, s[44:47], s71 offen sc1
    s_add_u32 s71, s71, 4352
    buffer_load_dwordx2 v[92:93], v105, s[44:47], s71 offen sc1
    s_add_u32 s71, s71, 4352
    buffer_load_dwordx2 v[94:95], v105, s[44:47], s71 offen sc1
    s_mul_i32 s71, s100, 2176
    s_mul_i32 s72, s64, 68
    s_add_u32 s71, s71, s72
    s_add_u32 s71, s71, 139264
    s_waitcnt vmcnt(0)
    s_mov_b64 exec, -1
    v_pk_add_f32 v[64:65], v[64:65], v[66:67]
    v_pk_add_f32 v[68:69], v[68:69], v[70:71]
    v_pk_add_f32 v[72:73], v[72:73], v[74:75]
    v_pk_add_f32 v[76:77], v[76:77], v[78:79]
    v_pk_add_f32 v[80:81], v[80:81], v[82:83]
    v_pk_add_f32 v[84:85], v[84:85], v[86:87]
    v_pk_add_f32 v[88:89], v[88:89], v[90:91]
    v_pk_add_f32 v[92:93], v[92:93], v[94:95]
    v_pk_add_f32 v[64:65], v[64:65], v[68:69]
    v_pk_add_f32 v[72:73], v[72:73], v[76:77]
    v_pk_add_f32 v[80:81], v[80:81], v[84:85]
    v_pk_add_f32 v[88:89], v[88:89], v[92:93]
    v_pk_add_f32 v[64:65], v[64:65], v[72:73]
    v_pk_add_f32 v[80:81], v[80:81], v[88:89]
    v_pk_add_f32 v[64:65], v[64:65], v[80:81]
    v_mov_b64 v[66:67], v[64:65]
    s_nop 1
    v_permlane32_swap_b32 v64, v66
    v_permlane32_swap_b32 v65, v67
    v_pk_add_f32 v[64:65], v[64:65], v[66:67]
    v_cvt_pk_bf16_f32 v64, v64, v65
    s_mov_b64 exec, 0x1ffff
    buffer_store_dword v64, v104, s[44:47], s71 offen sc1
    s_mov_b64 exec, 1
    s_lshr_b32 s71, s64, 3
    s_lshl2_add_u32 s71, s100, s71
    s_lshl_b32 s71, s71, 8
    s_and_b32 s72, s64, 7
    s_lshl2_add_u32 s71, s72, s71
    s_add_u32 s71, s71, 1310720
    s_waitcnt vmcnt(0)
    buffer_store_dword v10, off, s[44:47], s71 offset:64 sc1
    s_mov_b64 exec, -1
L_nol1:
    s_add_u32 s71, s79, 98304
    s_mov_b32 m0, s71
    s_nop 0
    s_waitcnt vmcnt(2)
    buffer_load_dwordx4 v1, s[44:47], s71 offen offset:0 sc1 lds
    s_waitcnt vmcnt(2)
    buffer_load_dwordx4 v1, s[44:47], s71 offen offset:1024 sc1 lds
    s_waitcnt vmcnt(2)
    buffer_load_dwordx4 v1, s[44:47], s71 offen offset:2048 sc1 lds
    s_waitcnt vmcnt(2)
    buffer_load_dwordx4 v1, s[44:47], s71 offen offset:3072 sc1 lds
    s_add_u32 s71, s79, 114688
    s_mov_b32 m0, s71
    s_nop 0
    s_waitcnt vmcnt(2)
    buffer_load_dwordx4 v1, s[44:47], s71 offen offset:0 sc1 lds
    s_waitcnt vmcnt(2)
    buffer_load_dwordx4 v1, s[44:47], s71 offen offset:1024 sc1 lds
    s_waitcnt vmcnt(2)
    buffer_load_dwordx4 v1, s[44:47], s71 offen offset:2048 sc1 lds
    s_waitcnt vmcnt(2)
    buffer_load_dwordx4 v1, s[44:47], s71 offen offset:3072 sc1 lds
    s_mov_b64 exec, 1
    s_waitcnt vmcnt(0)
    ds_add_u32 v163, v13 offset:0
    s_mov_b64 exec, -1
    s_cmp_eq_u32 s70, 0
    s_cbranch_scc0 L_nol2
    s_mov_b32 s82, 262144
L_gp_s3:
    s_sleep 12
L_gf_s3:
    buffer_load_dwordx4 v[100:103], v109, s[44:47], 0 offen offset:64 sc1
    s_sub_u32 s82, s82, 1
    s_cmp_eq_u32 s82, 0
    s_cbranch_scc1 L_gd_s3
L_gc_s3:
    s_waitcnt vmcnt(0)
    v_min3_u32 v25, v100, v101, v102
    v_min_u32 v25, v25, v103
    v_cmp_gt_u32 vcc, 1, v25
    s_nop 0
    s_cbranch_vccnz L_gp_s3
L_gd_s3:
    s_mov_b64 exec, 1
    ds_add_u32 v163, v14
    s_mov_b64 exec, -1
    s_branch L_lp_s3d
L_nol2:
    s_mov_b32 s82, 1048576
L_lp_s3:
    s_sleep 16
L_lq_s3:
    ds_read_b32 v9, v163 offset:0
    s_sub_u32 s82, s82, 1
    s_cmp_eq_u32 s82, 0
    s_cbranch_scc1 L_lp_s3d
    s_waitcnt lgkmcnt(0)
    v_readfirstlane_b32 s72, v9
    s_nop 0
    s_and_b32 s72, s72, 48
    s_cmp_lt_u32 s72, 16
    s_cbranch_scc1 L_lp_s3
L_lp_s3d:
    s_lshl_b32 s93, s85, 17
    s_add_u32 s93, s93, s92
    s_add_u32 m0, s92, 131072
    s_add_u32 s71, s93, 7446528
    s_waitcnt vmcnt(2)
    buffer_load_dwordx4 v1, s[44:47], s71 offen sc1 lds
    s_waitcnt vmcnt(2)
    buffer_load_dwordx4 v1, s[44:47], s71 offen offset:1024 sc1 lds
    s_add_u32 m0, s92, 139264
    s_add_u32 s71, s93, 7454720
    s_waitcnt vmcnt(2)
    buffer_load_dwordx4 v1, s[44:47], s71 offen sc1 lds
    s_waitcnt vmcnt(2)
    buffer_load_dwordx4 v1, s[44:47], s71 offen offset:1024 sc1 lds
    s_add_u32 m0, s92, 147456
    s_add_u32 s71, s93, 7462912
    s_waitcnt vmcnt(2)
    buffer_load_dwordx4 v1, s[44:47], s71 offen sc1 lds
    s_waitcnt vmcnt(2)
    buffer_load_dwordx4 v1, s[44:47], s71 offen offset:1024 sc1 lds
    s_mov_b32 s82, 1048576
    s_branch L_lq_prog0
L_lp_prog0:
    s_sleep 16
L_lq_prog0:
    ds_read_b32 v9, v163 offset:4
    s_sub_u32 s82, s82, 1
    s_cmp_eq_u32 s82, 0
    s_cbranch_scc1 L_lp_prog0d
    s_waitcnt lgkmcnt(0)
    v_readfirstlane_b32 s72, v9
    s_nop 0
    s_cmp_lt_u32 s72, 8
    s_cbranch_scc1 L_lp_prog0
L_lp_prog0d:
    s_add_u32 m0, s92, 0
    s_add_u32 s71, s93, 7340032
    s_waitcnt vmcnt(2)
    buffer_load_dwordx4 v1, s[44:47], s71 offen sc1 lds
    s_waitcnt vmcnt(2)
    buffer_load_dwordx4 v1, s[44:47], s71 offen offset:1024 sc1 lds
    s_add_u32 m0, s92, 8192
    s_add_u32 s71, s93, 7348224
    s_waitcnt vmcnt(2)
    buffer_load_dwordx4 v1, s[44:47], s71 offen sc1 lds
    s_waitcnt vmcnt(2)
    buffer_load_dwordx4 v1, s[44:47], s71 offen offset:1024 sc1 lds
    s_add_u32 m0, s92, 16384
    s_add_u32 s71, s93, 7356416
    s_waitcnt vmcnt(2)
    buffer_load_dwordx4 v1, s[44:47], s71 offen sc1 lds
    s_waitcnt vmcnt(2)
    buffer_load_dwordx4 v1, s[44:47], s71 offen offset:1024 sc1 lds
    s_add_u32 m0, s92, 24576
    s_add_u32 s71, s93, 7364608
    s_waitcnt vmcnt(2)
    buffer_load_dwordx4 v1, s[44:47], s71 offen sc1 lds
    s_waitcnt vmcnt(2)
    buffer_load_dwordx4 v1, s[44:47], s71 offen offset:1024 sc1 lds
    s_add_u32 m0, s92, 32768
    s_add_u32 s71, s93, 7372800
    s_waitcnt vmcnt(2)
    buffer_load_dwordx4 v1, s[44:47], s71 offen sc1 lds
    s_waitcnt vmcnt(2)
    buffer_load_dwordx4 v1, s[44:47], s71 offen offset:1024 sc1 lds
    s_add_u32 m0, s92, 40960
    s_add_u32 s71, s93, 7380992
    s_waitcnt vmcnt(2)
    buffer_load_dwordx4 v1, s[44:47], s71 offen sc1 lds
    s_waitcnt vmcnt(2)
    buffer_load_dwordx4 v1, s[44:47], s71 offen offset:1024 sc1 lds
    s_add_u32 m0, s92, 49152
    s_add_u32 s71, s93, 7389184
    s_waitcnt vmcnt(2)
    buffer_load_dwordx4 v1, s[44:47], s71 offen sc1 lds
    s_waitcnt vmcnt(2)
    buffer_load_dwordx4 v1, s[44:47], s71 offen offset:1024 sc1 lds
    s_mov_b64 exec, 1
    s_waitcnt vmcnt(0)
    ds_add_u32 v163, v10 offset:16
    s_mov_b64 exec, -1
    s_mov_b32 s82, 1048576
    s_branch L_lq_prog1
L_lp_prog1:
    s_sleep 16
L_lq_prog1:
    ds_read_b32 v9, v163 offset:8
    s_sub_u32 s82, s82, 1
    s_cmp_eq_u32 s82, 0
    s_cbranch_scc1 L_lp_prog1d
    s_waitcnt lgkmcnt(0)
    v_readfirstlane_b32 s72, v9
    s_nop 0
    s_cmp_lt_u32 s72, 8
    s_cbranch_scc1 L_lp_prog1
L_lp_prog1d:
    s_add_u32 m0, s92, 57344
    s_add_u32 s71, s93, 7397376
    s_waitcnt vmcnt(2)
    buffer_load_dwordx4 v1, s[44:47], s71 offen sc1 lds
    s_waitcnt vmcnt(2)
    buffer_load_dwordx4 v1, s[44:47], s71 offen offset:1024 sc1 lds
    s_add_u32 m0, s92, 65536
    s_add_u32 s71, s93, 7405568
    s_waitcnt vmcnt(2)
    buffer_load_dwordx4 v1, s[44:47], s71 offen sc1 lds
    s_waitcnt vmcnt(2)
    buffer_load_dwordx4 v1, s[44:47], s71 offen offset:1024 sc1 lds
    s_add_u32 m0, s92, 73728
    s_add_u32 s71, s93, 7413760
    s_waitcnt vmcnt(2)
    buffer_load_dwordx4 v1, s[44:47], s71 offen sc1 lds
    s_waitcnt vmcnt(2)
    buffer_load_dwordx4 v1, s[44:47], s71 offen offset:1024 sc1 lds
    s_add_u32 m0, s92, 81920
    s_add_u32 s71, s93, 7421952
    s_waitcnt vmcnt(2)
    buffer_load_dwordx4 v1, s[44:47], s71 offen sc1 lds
    s_waitcnt vmcnt(2)
    buffer_load_dwordx4 v1, s[44:47], s71 offen offset:1024 sc1 lds
    s_mov_b32 s82, 1048576
L_lp_prog2:
    s_sleep 16
L_lq_prog2:
    ds_read_b32 v9, v163 offset:12
    s_sub_u32 s82, s82, 1
    s_cmp_eq_u32 s82, 0
    s_cbranch_scc1 L_lp_prog2d
    s_waitcnt lgkmcnt(0)
    v_readfirstlane_b32 s72, v9
    s_nop 0
    s_cmp_lt_u32 s72, 8
    s_cbranch_scc1 L_lp_prog2
L_lp_prog2d:
    s_add_u32 m0, s92, 90112
    s_add_u32 s71, s93, 7430144
    s_waitcnt vmcnt(2)
    buffer_load_dwordx4 v1, s[44:47], s71 offen sc1 lds
    s_waitcnt vmcnt(2)
    buffer_load_dwordx4 v1, s[44:47], s71 offen offset:1024 sc1 lds
    s_add_u32 m0, s92, 98304
    s_add_u32 s71, s93, 7438336
    s_waitcnt vmcnt(2)
    buffer_load_dwordx4 v1, s[44:47], s71 offen sc1 lds
    s_waitcnt vmcnt(2)
    buffer_load_dwordx4 v1, s[44:47], s71 offen offset:1024 sc1 lds
    s_waitcnt vmcnt(0)
    s_barrier
    s_endpgm
L_codeend:
.section .rodata,"a"
.p2align 6
.amdhsa_kernel gated_mix__grouped_kv_mqa__linear_attn_block__prompt_kernel
  .amdhsa_next_free_vgpr 168
  .amdhsa_next_free_sgpr 102
  .amdhsa_accum_offset 168
  .amdhsa_group_segment_fixed_size 0
  .amdhsa_kernarg_size 96
  .amdhsa_user_sgpr_count 2
  .amdhsa_user_sgpr_kernarg_segment_ptr 1
  .amdhsa_system_sgpr_workgroup_id_x 1
.end_amdhsa_kernel
```
